```python
import torch

def _softmax(x, axis=-1):
    return torch.softmax(x, dim=axis)

def _gelu(x):
    return torch.nn.functional.gelu(x, approximate='tanh')

def _silu(x):
    return torch.nn.functional.silu(x)

def _sigmoid(x):
    return torch.sigmoid(x)

def _layernorm(x, axis=-1, eps=1e-05):
    m = x.mean(dim=axis, keepdim=True)
    v = x.var(dim=axis, keepdim=True, unbiased=False)
    return (x - m) / torch.sqrt(v + eps)

def _scatter_add(tgt, idx, src, axis=0):
    return tgt.clone().index_add_(axis, idx, src)

def _segment_sum(src, seg, n):
    out = torch.zeros((n,) + src.shape[1:], dtype=src.dtype)
    return out.index_add_(0, seg, src)

def _pad(x, pw):
    flat = tuple((v for pair in reversed(pw) for v in pair))
    return torch.nn.functional.pad(x, flat)
kernel_name = 'adaLN_cond__gqa_block_cached__glu_gated_geglu__decode'

def setup_inputs():

    _w = lambda a: (lambda t: t.to(torch.bfloat16) if t.is_floating_point() else t)(torch.as_tensor(a))

    def _A_setup():
        B, Sq, D = (1, 1, 512)
        Hq, Hkv, Sk, Dh = (32, 32, 4096, 128)
        assert Hq % Hkv == 0, (Hq, Hkv)
        return {'x': _w((lambda *s: torch.randn(*s, dtype=torch.bfloat16) * 0.05)(B, Sq, D)), 'k_cache': _w((lambda *s: torch.randn(*s, dtype=torch.bfloat16) * 3.2)(B, Hkv, Sk, Dh)), 'v_cache': _w((lambda *s: torch.randn(*s, dtype=torch.bfloat16) * 3.2)(B, Hkv, Sk, Dh)), 'wq': _w((lambda *s: torch.randn(*s, dtype=torch.bfloat16) * 3.2)(D, Hq * Dh) * D ** (-0.5)), 'wo': _w((lambda *s: torch.randn(*s, dtype=torch.bfloat16) * 3.2)(Hq * Dh, D) * (Hq * Dh) ** (-0.5))}
    _A_in = _A_setup()

    def _B_setup():
        B, S, Dm, Df = (1, 1, 512, 1376)
        return {'x': _w((lambda *s: torch.randn(*s, dtype=torch.bfloat16) * 0.05)(B, S, Dm)), 'w_gate': _w((lambda *s: torch.randn(*s, dtype=torch.bfloat16) * 3.2)(Dm, Df) * Dm ** (-0.5)), 'w_up': _w((lambda *s: torch.randn(*s, dtype=torch.bfloat16) * 3.2)(Dm, Df) * Dm ** (-0.5)), 'w_down': _w((lambda *s: torch.randn(*s, dtype=torch.bfloat16) * 3.2)(Df, Dm) * Df ** (-0.5))}
    _B_in = _B_setup()
    return {'A_x': _A_in['x'], 'A_k_cache': _A_in['k_cache'], 'A_v_cache': _A_in['v_cache'], 'A_wq': _A_in['wq'], 'A_wo': _A_in['wo'], 'B_x': _B_in['x'], 'B_w_gate': _B_in['w_gate'], 'B_w_up': _B_in['w_up'], 'B_w_down': _B_in['w_down'], 'c': _w((lambda *s: torch.randn(*s, dtype=torch.bfloat16) * 0.2)(1, 512) * 8.0), 'w_mod': _w((lambda *s: torch.randn(*s, dtype=torch.bfloat16) * 0.2)(512, 6 * 512) * 512 ** (-0.5) * 8.0)}

def reference(A_x, A_k_cache, A_v_cache, A_wq, A_wo, B_x, B_w_gate, B_w_up, B_w_down, c, w_mod):

    def _A_ref(x, k_cache, v_cache, wq, wo):
        B, Sq, D = x.shape
        Hq, Dh = (32, 128)
        Hkv = k_cache.shape[1]
        rep = Hq // Hkv
        q = (lambda x, *d: x.permute(*d))((x @ wq).reshape(B, Sq, Hq, Dh), 0, 2, 1, 3)
        k = (lambda x, n, axis: torch.repeat_interleave(x, n, dim=axis))(k_cache, rep, axis=1)
        v = (lambda x, n, axis: torch.repeat_interleave(x, n, dim=axis))(v_cache, rep, axis=1)
        scores = torch.einsum('bhqd,bhkd->bhqk', q, k) * Dh ** (-0.5)
        p = _softmax(scores, axis=-1)
        o = torch.einsum('bhqk,bhkd->bhqd', p, v)
        return (lambda x, *d: x.permute(*d))(o, 0, 2, 1, 3).reshape(B, Sq, Hq * Dh) @ wo

    def _B_ref(x, w_gate, w_up, w_down):
        g = torch.einsum('bsd,df->bsf', x, w_gate)
        u = torch.einsum('bsd,df->bsf', x, w_up)
        h = _gelu(g) * u
        return torch.einsum('bsf,fd->bsd', h, w_down)
    x = A_x
    mod = (_silu(c) @ w_mod).reshape(c.shape[0], 6, 1, -1)
    sa, ca, ga, sb, cb, gb = (mod[:, 0].clone(), mod[:, 1].clone(), mod[:, 2].clone(), mod[:, 3].clone(), mod[:, 4].clone(), mod[:, 5].clone())
    h = _layernorm(x, axis=-1) * (1 + ca) + sa
    x = x + ga * _A_ref(h, A_k_cache, A_v_cache, A_wq, A_wo)
    h = _layernorm(x, axis=-1) * (1 + cb) + sb
    x = x + gb * _B_ref(h, B_w_gate, B_w_up, B_w_down)
    return x
```

```asm
; @launch grid=(256,1,1) block=(640,1,1) lds=81920
.amdgcn_target "amdgcn-amd-amdhsa--gfx950"
.text
.globl adaLN_cond__gqa_block_cached__glu_gated_geglu__decode_kernel
.p2align 8
.type adaLN_cond__gqa_block_cached__glu_gated_geglu__decode_kernel,@function
adaLN_cond__gqa_block_cached__glu_gated_geglu__decode_kernel:
    s_cmp_ge_u32 s2, 256
    s_cbranch_scc1 L_end
    s_load_dwordx16 s[8:23], s[0:1], 0
    s_load_dwordx8 s[24:31], s[0:1], 64
    s_load_dwordx4 s[32:35], s[0:1], 96
    v_lshrrev_b32 v1, 6, v0
    v_and_b32 v0, 63, v0
    v_readfirstlane_b32 s3, v1
    s_add_u32 s58, s3, 2
    s_sub_u32 s59, s3, 4
    s_cmp_lt_u32 s3, 4
    s_cselect_b32 s59, s58, s59
    s_cmp_lt_u32 s3, 6
    s_cselect_b32 s3, s59, s3
    s_and_b32 s7, s2, 7
    s_lshr_b32 s88, s2, 3
    s_lshr_b32 s5, s88, 3
    s_lshl_b32 s4, s7, 2
    s_add_u32 s4, s4, s5
    s_and_b32 s5, s88, 7
    s_min_u32 s90, s7, 3
    s_mul_i32 s89, s7, 5
    s_add_u32 s90, s90, s89
    s_cmp_lt_u32 s7, 3
    s_cselect_b32 s89, 6, 5
    s_mov_b64 s[56:57], -1
    s_mov_b32 s94, 0x10001
    s_mov_b32 s95, 0x10001
    s_lshl_b32 s75, s7, 5
    s_add_u32 s75, s75, s88
    s_lshl_b32 s74, s75, 12
    v_lshlrev_b32 v1, 4, v0
    s_waitcnt lgkmcnt(0)
    s_load_dword s6, s[34:35], 0
    s_add_u32 s74, s74, 1048576
    s_mov_b32 s96, 2097152
    s_mov_b32 s97, 0xfffffffe
    s_mov_b32 s36, s34
    s_and_b32 s37, s35, 0xffff
    s_mov_b32 s38, 4194304
    s_mov_b32 s39, 0x20000
    s_cmp_lt_u32 s3, 2
    s_cbranch_scc1 L_helpers
    s_sub_u32 s58, s3, 2
    s_and_b32 s59, s58, 3
    s_cmp_ge_u32 s3, 6
    s_cselect_b32 s40, s12, s10
    s_cselect_b32 s41, s13, s11
    s_lshl_b32 s60, s4, 20
    s_lshl_b32 s61, s5, 17
    s_add_u32 s60, s60, s61
    s_lshl_b32 s61, s59, 15
    s_add_u32 s60, s60, s61
    s_add_u32 s40, s40, s60
    s_addc_u32 s41, s41, 0
    s_and_b32 s41, s41, 0xffff
    s_mov_b32 s42, 32768
    s_mov_b32 s43, 0x20000
    s_cmp_ge_u32 s3, 6
    s_cbranch_scc1 L_vwave0
    s_mov_b32 s62, 0
    buffer_load_dwordx4 v[8:11], v1, s[40:43], s62 offen offset:0 nt
    buffer_load_dwordx4 v[12:15], v1, s[40:43], s62 offen offset:1024 nt
    buffer_load_dwordx4 v[16:19], v1, s[40:43], s62 offen offset:2048 nt
    buffer_load_dwordx4 v[20:23], v1, s[40:43], s62 offen offset:3072 nt
    s_barrier
    s_movk_i32 s62, 4096
    s_waitcnt vmcnt(3)
    buffer_load_dwordx4 v[24:27], v1, s[40:43], s62 offen offset:0 nt
    s_waitcnt vmcnt(3)
    buffer_load_dwordx4 v[28:31], v1, s[40:43], s62 offen offset:1024 nt
    s_waitcnt vmcnt(3)
    buffer_load_dwordx4 v[32:35], v1, s[40:43], s62 offen offset:2048 nt
    s_waitcnt vmcnt(3)
    buffer_load_dwordx4 v[36:39], v1, s[40:43], s62 offen offset:3072 nt
    s_movk_i32 s62, 8192
    s_waitcnt vmcnt(3)
    buffer_load_dwordx4 v[40:43], v1, s[40:43], s62 offen offset:0 nt
    s_waitcnt vmcnt(3)
    buffer_load_dwordx4 v[44:47], v1, s[40:43], s62 offen offset:1024 nt
    s_waitcnt vmcnt(3)
    buffer_load_dwordx4 v[48:51], v1, s[40:43], s62 offen offset:2048 nt
    s_waitcnt vmcnt(3)
    buffer_load_dwordx4 v[52:55], v1, s[40:43], s62 offen offset:3072 nt
    s_waitcnt lgkmcnt(0)
    s_mul_i32 s6, s6, 0x9E3779B1
    s_add_u32 s6, s6, 0x7F4A7C15
    s_or_b32 s6, s6, 1
    v_mov_b32 v2, s6
    v_mov_b32 v3, 0
    s_lshl_b32 s63, s59, 2
    v_mov_b32 v4, s63
    s_movk_i32 s62, 12288
    s_waitcnt vmcnt(3)
    buffer_load_dwordx4 v[56:59], v1, s[40:43], s62 offen offset:0 nt
    s_waitcnt vmcnt(3)
    buffer_load_dwordx4 v[60:63], v1, s[40:43], s62 offen offset:1024 nt
    s_waitcnt vmcnt(3)
    buffer_load_dwordx4 v[64:67], v1, s[40:43], s62 offen offset:2048 nt
    s_waitcnt vmcnt(3)
    buffer_load_dwordx4 v[68:71], v1, s[40:43], s62 offen offset:3072 nt
    s_movk_i32 s62, 16384
    s_waitcnt vmcnt(3)
    buffer_load_dwordx4 v[72:75], v1, s[40:43], s62 offen offset:0 nt
    s_waitcnt vmcnt(3)
    buffer_load_dwordx4 v[76:79], v1, s[40:43], s62 offen offset:1024 nt
    s_waitcnt vmcnt(3)
    buffer_load_dwordx4 v[80:83], v1, s[40:43], s62 offen offset:2048 nt
    s_waitcnt vmcnt(3)
    buffer_load_dwordx4 v[84:87], v1, s[40:43], s62 offen offset:3072 nt
    s_movk_i32 s62, 20480
    s_waitcnt vmcnt(3)
    buffer_load_dwordx4 v[88:91], v1, s[40:43], s62 offen offset:0 nt
    s_waitcnt vmcnt(3)
    buffer_load_dwordx4 v[92:95], v1, s[40:43], s62 offen offset:1024 nt
    s_waitcnt vmcnt(3)
    buffer_load_dwordx4 v[96:99], v1, s[40:43], s62 offen offset:2048 nt
    s_waitcnt vmcnt(3)
    buffer_load_dwordx4 v[100:103], v1, s[40:43], s62 offen offset:3072 nt
    s_movk_i32 s62, 24576
    s_waitcnt vmcnt(3)
    buffer_load_dwordx4 v[104:107], v1, s[40:43], s62 offen offset:0 nt
    s_waitcnt vmcnt(3)
    buffer_load_dwordx4 v[108:111], v1, s[40:43], s62 offen offset:1024 nt
    s_waitcnt vmcnt(3)
    buffer_load_dwordx4 v[112:115], v1, s[40:43], s62 offen offset:2048 nt
    s_waitcnt vmcnt(3)
    buffer_load_dwordx4 v[116:119], v1, s[40:43], s62 offen offset:3072 nt
    ds_write_b32 v4, v2 offset:96
    s_movk_i32 s62, 28672
    s_waitcnt vmcnt(3)
    buffer_load_dwordx4 v[120:123], v1, s[40:43], s62 offen offset:0 nt
    s_waitcnt vmcnt(3)
    buffer_load_dwordx4 v[124:127], v1, s[40:43], s62 offen offset:1024 nt
    s_waitcnt vmcnt(3)
    buffer_load_dwordx4 v[128:131], v1, s[40:43], s62 offen offset:2048 nt
    s_waitcnt vmcnt(3)
    buffer_load_dwordx4 v[132:135], v1, s[40:43], s62 offen offset:3072 nt
    v_and_b32 v150, 15, v0
    v_lshlrev_b32 v150, 4, v150
    s_mov_b32 s68, 2097152
L_spin_1:
    ds_read_b32 v151, v3 offset:0
    ds_read_b128 v[4:7], v150 offset:256
    s_waitcnt lgkmcnt(0)
    v_cmp_ne_u32 vcc, v151, v2
    s_cbranch_vccz L_spinx_2
    s_sleep 2
    s_sub_u32 s68, s68, 1
    s_cbranch_scc0 L_spin_1
L_spinx_2:
    s_waitcnt vmcnt(28)
    v_dot2_f32_bf16 v8, v8, v4, 0
    v_dot2_f32_bf16 v12, v12, v4, 0
    v_dot2_f32_bf16 v16, v16, v4, 0
    v_dot2_f32_bf16 v20, v20, v4, 0
    v_dot2_f32_bf16 v8, v9, v5, v8
    v_dot2_f32_bf16 v12, v13, v5, v12
    v_dot2_f32_bf16 v16, v17, v5, v16
    v_dot2_f32_bf16 v20, v21, v5, v20
    v_dot2_f32_bf16 v8, v10, v6, v8
    v_dot2_f32_bf16 v12, v14, v6, v12
    v_dot2_f32_bf16 v16, v18, v6, v16
    v_dot2_f32_bf16 v20, v22, v6, v20
    v_dot2_f32_bf16 v8, v11, v7, v8
    v_dot2_f32_bf16 v12, v15, v7, v12
    v_dot2_f32_bf16 v16, v19, v7, v16
    v_dot2_f32_bf16 v20, v23, v7, v20
    s_waitcnt vmcnt(24)
    v_dot2_f32_bf16 v24, v24, v4, 0
    v_dot2_f32_bf16 v28, v28, v4, 0
    v_dot2_f32_bf16 v32, v32, v4, 0
    v_dot2_f32_bf16 v36, v36, v4, 0
    v_dot2_f32_bf16 v24, v25, v5, v24
    v_dot2_f32_bf16 v28, v29, v5, v28
    v_dot2_f32_bf16 v32, v33, v5, v32
    v_dot2_f32_bf16 v36, v37, v5, v36
    v_dot2_f32_bf16 v24, v26, v6, v24
    v_dot2_f32_bf16 v28, v30, v6, v28
    v_dot2_f32_bf16 v32, v34, v6, v32
    v_dot2_f32_bf16 v36, v38, v6, v36
    v_dot2_f32_bf16 v24, v27, v7, v24
    v_dot2_f32_bf16 v28, v31, v7, v28
    v_dot2_f32_bf16 v32, v35, v7, v32
    v_dot2_f32_bf16 v36, v39, v7, v36
    s_waitcnt vmcnt(20)
    v_dot2_f32_bf16 v40, v40, v4, 0
    v_dot2_f32_bf16 v44, v44, v4, 0
    v_dot2_f32_bf16 v48, v48, v4, 0
    v_dot2_f32_bf16 v52, v52, v4, 0
    v_dot2_f32_bf16 v40, v41, v5, v40
    v_dot2_f32_bf16 v44, v45, v5, v44
    v_dot2_f32_bf16 v48, v49, v5, v48
    v_dot2_f32_bf16 v52, v53, v5, v52
    v_dot2_f32_bf16 v40, v42, v6, v40
    v_dot2_f32_bf16 v44, v46, v6, v44
    v_dot2_f32_bf16 v48, v50, v6, v48
    v_dot2_f32_bf16 v52, v54, v6, v52
    v_dot2_f32_bf16 v40, v43, v7, v40
    v_dot2_f32_bf16 v44, v47, v7, v44
    v_dot2_f32_bf16 v48, v51, v7, v48
    v_dot2_f32_bf16 v52, v55, v7, v52
    s_waitcnt vmcnt(16)
    v_dot2_f32_bf16 v56, v56, v4, 0
    v_dot2_f32_bf16 v60, v60, v4, 0
    v_dot2_f32_bf16 v64, v64, v4, 0
    v_dot2_f32_bf16 v68, v68, v4, 0
    v_dot2_f32_bf16 v56, v57, v5, v56
    v_dot2_f32_bf16 v60, v61, v5, v60
    v_dot2_f32_bf16 v64, v65, v5, v64
    v_dot2_f32_bf16 v68, v69, v5, v68
    v_dot2_f32_bf16 v56, v58, v6, v56
    v_dot2_f32_bf16 v60, v62, v6, v60
    v_dot2_f32_bf16 v64, v66, v6, v64
    v_dot2_f32_bf16 v68, v70, v6, v68
    v_dot2_f32_bf16 v56, v59, v7, v56
    v_dot2_f32_bf16 v60, v63, v7, v60
    v_dot2_f32_bf16 v64, v67, v7, v64
    v_dot2_f32_bf16 v68, v71, v7, v68
    v_add_f32_dpp v8, v8, v8 row_ror:8 row_mask:0xf bank_mask:0x3
    v_add_f32_dpp v12, v12, v12 row_ror:8 row_mask:0xf bank_mask:0x3
    v_add_f32_dpp v16, v16, v16 row_ror:8 row_mask:0xf bank_mask:0x3
    v_add_f32_dpp v20, v20, v20 row_ror:8 row_mask:0xf bank_mask:0x3
    v_add_f32_dpp v24, v24, v24 row_ror:8 row_mask:0xf bank_mask:0x3
    v_add_f32_dpp v28, v28, v28 row_ror:8 row_mask:0xf bank_mask:0x3
    v_add_f32_dpp v32, v32, v32 row_ror:8 row_mask:0xf bank_mask:0x3
    v_add_f32_dpp v36, v36, v36 row_ror:8 row_mask:0xf bank_mask:0x3
    v_add_f32_dpp v8, v40, v40 row_ror:8 row_mask:0xf bank_mask:0xc
    v_add_f32_dpp v12, v44, v44 row_ror:8 row_mask:0xf bank_mask:0xc
    v_add_f32_dpp v16, v48, v48 row_ror:8 row_mask:0xf bank_mask:0xc
    v_add_f32_dpp v20, v52, v52 row_ror:8 row_mask:0xf bank_mask:0xc
    v_add_f32_dpp v24, v56, v56 row_ror:8 row_mask:0xf bank_mask:0xc
    v_add_f32_dpp v28, v60, v60 row_ror:8 row_mask:0xf bank_mask:0xc
    v_add_f32_dpp v32, v64, v64 row_ror:8 row_mask:0xf bank_mask:0xc
    v_add_f32_dpp v36, v68, v68 row_ror:8 row_mask:0xf bank_mask:0xc
    v_add_f32_dpp v8, v8, v8 row_half_mirror row_mask:0xf bank_mask:0x5
    v_add_f32_dpp v12, v12, v12 row_half_mirror row_mask:0xf bank_mask:0x5
    v_add_f32_dpp v16, v16, v16 row_half_mirror row_mask:0xf bank_mask:0x5
    v_add_f32_dpp v20, v20, v20 row_half_mirror row_mask:0xf bank_mask:0x5
    v_add_f32_dpp v8, v24, v24 row_half_mirror row_mask:0xf bank_mask:0xa
    v_add_f32_dpp v12, v28, v28 row_half_mirror row_mask:0xf bank_mask:0xa
    v_add_f32_dpp v16, v32, v32 row_half_mirror row_mask:0xf bank_mask:0xa
    v_add_f32_dpp v20, v36, v36 row_half_mirror row_mask:0xf bank_mask:0xa
    v_add_f32_dpp v8, v8, v8 quad_perm:[1,0,3,2] row_mask:0xf bank_mask:0xf
    v_add_f32_dpp v12, v12, v12 quad_perm:[1,0,3,2] row_mask:0xf bank_mask:0xf
    v_add_f32_dpp v16, v16, v16 quad_perm:[1,0,3,2] row_mask:0xf bank_mask:0xf
    v_add_f32_dpp v20, v20, v20 quad_perm:[1,0,3,2] row_mask:0xf bank_mask:0xf
    v_add_f32_dpp v8, v8, v8 quad_perm:[2,3,0,1] row_mask:0xf bank_mask:0xf
    v_add_f32_dpp v12, v12, v12 quad_perm:[2,3,0,1] row_mask:0xf bank_mask:0xf
    v_add_f32_dpp v16, v16, v16 quad_perm:[2,3,0,1] row_mask:0xf bank_mask:0xf
    v_add_f32_dpp v20, v20, v20 quad_perm:[2,3,0,1] row_mask:0xf bank_mask:0xf
    s_waitcnt vmcnt(12)
    v_dot2_f32_bf16 v72, v72, v4, 0
    v_dot2_f32_bf16 v76, v76, v4, 0
    v_dot2_f32_bf16 v80, v80, v4, 0
    v_dot2_f32_bf16 v84, v84, v4, 0
    v_dot2_f32_bf16 v72, v73, v5, v72
    v_dot2_f32_bf16 v76, v77, v5, v76
    v_dot2_f32_bf16 v80, v81, v5, v80
    v_dot2_f32_bf16 v84, v85, v5, v84
    v_dot2_f32_bf16 v72, v74, v6, v72
    v_dot2_f32_bf16 v76, v78, v6, v76
    v_dot2_f32_bf16 v80, v82, v6, v80
    v_dot2_f32_bf16 v84, v86, v6, v84
    v_dot2_f32_bf16 v72, v75, v7, v72
    v_dot2_f32_bf16 v76, v79, v7, v76
    v_dot2_f32_bf16 v80, v83, v7, v80
    v_dot2_f32_bf16 v84, v87, v7, v84
    s_waitcnt vmcnt(8)
    v_dot2_f32_bf16 v88, v88, v4, 0
    v_dot2_f32_bf16 v92, v92, v4, 0
    v_dot2_f32_bf16 v96, v96, v4, 0
    v_dot2_f32_bf16 v100, v100, v4, 0
    v_dot2_f32_bf16 v88, v89, v5, v88
    v_dot2_f32_bf16 v92, v93, v5, v92
    v_dot2_f32_bf16 v96, v97, v5, v96
    v_dot2_f32_bf16 v100, v101, v5, v100
    v_dot2_f32_bf16 v88, v90, v6, v88
    v_dot2_f32_bf16 v92, v94, v6, v92
    v_dot2_f32_bf16 v96, v98, v6, v96
    v_dot2_f32_bf16 v100, v102, v6, v100
    v_dot2_f32_bf16 v88, v91, v7, v88
    v_dot2_f32_bf16 v92, v95, v7, v92
    v_dot2_f32_bf16 v96, v99, v7, v96
    v_dot2_f32_bf16 v100, v103, v7, v100
    s_waitcnt vmcnt(4)
    v_dot2_f32_bf16 v104, v104, v4, 0
    v_dot2_f32_bf16 v108, v108, v4, 0
    v_dot2_f32_bf16 v112, v112, v4, 0
    v_dot2_f32_bf16 v116, v116, v4, 0
    v_dot2_f32_bf16 v104, v105, v5, v104
    v_dot2_f32_bf16 v108, v109, v5, v108
    v_dot2_f32_bf16 v112, v113, v5, v112
    v_dot2_f32_bf16 v116, v117, v5, v116
    v_dot2_f32_bf16 v104, v106, v6, v104
    v_dot2_f32_bf16 v108, v110, v6, v108
    v_dot2_f32_bf16 v112, v114, v6, v112
    v_dot2_f32_bf16 v116, v118, v6, v116
    v_dot2_f32_bf16 v104, v107, v7, v104
    v_dot2_f32_bf16 v108, v111, v7, v108
    v_dot2_f32_bf16 v112, v115, v7, v112
    v_dot2_f32_bf16 v116, v119, v7, v116
    s_waitcnt vmcnt(0)
    v_dot2_f32_bf16 v120, v120, v4, 0
    v_dot2_f32_bf16 v124, v124, v4, 0
    v_dot2_f32_bf16 v128, v128, v4, 0
    v_dot2_f32_bf16 v132, v132, v4, 0
    v_dot2_f32_bf16 v120, v121, v5, v120
    v_dot2_f32_bf16 v124, v125, v5, v124
    v_dot2_f32_bf16 v128, v129, v5, v128
    v_dot2_f32_bf16 v132, v133, v5, v132
    v_dot2_f32_bf16 v120, v122, v6, v120
    v_dot2_f32_bf16 v124, v126, v6, v124
    v_dot2_f32_bf16 v128, v130, v6, v128
    v_dot2_f32_bf16 v132, v134, v6, v132
    v_dot2_f32_bf16 v120, v123, v7, v120
    v_dot2_f32_bf16 v124, v127, v7, v124
    v_dot2_f32_bf16 v128, v131, v7, v128
    v_dot2_f32_bf16 v132, v135, v7, v132
    v_add_f32_dpp v72, v72, v72 row_ror:8 row_mask:0xf bank_mask:0x3
    v_add_f32_dpp v76, v76, v76 row_ror:8 row_mask:0xf bank_mask:0x3
    v_add_f32_dpp v80, v80, v80 row_ror:8 row_mask:0xf bank_mask:0x3
    v_add_f32_dpp v84, v84, v84 row_ror:8 row_mask:0xf bank_mask:0x3
    v_add_f32_dpp v88, v88, v88 row_ror:8 row_mask:0xf bank_mask:0x3
    v_add_f32_dpp v92, v92, v92 row_ror:8 row_mask:0xf bank_mask:0x3
    v_add_f32_dpp v96, v96, v96 row_ror:8 row_mask:0xf bank_mask:0x3
    v_add_f32_dpp v100, v100, v100 row_ror:8 row_mask:0xf bank_mask:0x3
    v_add_f32_dpp v72, v104, v104 row_ror:8 row_mask:0xf bank_mask:0xc
    v_add_f32_dpp v76, v108, v108 row_ror:8 row_mask:0xf bank_mask:0xc
    v_add_f32_dpp v80, v112, v112 row_ror:8 row_mask:0xf bank_mask:0xc
    v_add_f32_dpp v84, v116, v116 row_ror:8 row_mask:0xf bank_mask:0xc
    v_add_f32_dpp v88, v120, v120 row_ror:8 row_mask:0xf bank_mask:0xc
    v_add_f32_dpp v92, v124, v124 row_ror:8 row_mask:0xf bank_mask:0xc
    v_add_f32_dpp v96, v128, v128 row_ror:8 row_mask:0xf bank_mask:0xc
    v_add_f32_dpp v100, v132, v132 row_ror:8 row_mask:0xf bank_mask:0xc
    v_add_f32_dpp v72, v72, v72 row_half_mirror row_mask:0xf bank_mask:0x5
    v_add_f32_dpp v76, v76, v76 row_half_mirror row_mask:0xf bank_mask:0x5
    v_add_f32_dpp v80, v80, v80 row_half_mirror row_mask:0xf bank_mask:0x5
    v_add_f32_dpp v84, v84, v84 row_half_mirror row_mask:0xf bank_mask:0x5
    v_add_f32_dpp v72, v88, v88 row_half_mirror row_mask:0xf bank_mask:0xa
    v_add_f32_dpp v76, v92, v92 row_half_mirror row_mask:0xf bank_mask:0xa
    v_add_f32_dpp v80, v96, v96 row_half_mirror row_mask:0xf bank_mask:0xa
    v_add_f32_dpp v84, v100, v100 row_half_mirror row_mask:0xf bank_mask:0xa
    v_add_f32_dpp v72, v72, v72 quad_perm:[1,0,3,2] row_mask:0xf bank_mask:0xf
    v_add_f32_dpp v76, v76, v76 quad_perm:[1,0,3,2] row_mask:0xf bank_mask:0xf
    v_add_f32_dpp v80, v80, v80 quad_perm:[1,0,3,2] row_mask:0xf bank_mask:0xf
    v_add_f32_dpp v84, v84, v84 quad_perm:[1,0,3,2] row_mask:0xf bank_mask:0xf
    v_add_f32_dpp v72, v72, v72 quad_perm:[2,3,0,1] row_mask:0xf bank_mask:0xf
    v_add_f32_dpp v76, v76, v76 quad_perm:[2,3,0,1] row_mask:0xf bank_mask:0xf
    v_add_f32_dpp v80, v80, v80 quad_perm:[2,3,0,1] row_mask:0xf bank_mask:0xf
    v_add_f32_dpp v84, v84, v84 quad_perm:[2,3,0,1] row_mask:0xf bank_mask:0xf
    s_mov_b32 s63, 1035273459
    v_cvt_pk_bf16_f32 v8, v8, v8
    v_cvt_pk_bf16_f32 v12, v12, v12
    v_cvt_pk_bf16_f32 v16, v16, v16
    v_cvt_pk_bf16_f32 v20, v20, v20
    v_cvt_pk_bf16_f32 v72, v72, v72
    v_cvt_pk_bf16_f32 v76, v76, v76
    v_cvt_pk_bf16_f32 v80, v80, v80
    v_cvt_pk_bf16_f32 v84, v84, v84
    v_and_b32 v8, 0xffff0000, v8
    v_and_b32 v12, 0xffff0000, v12
    v_and_b32 v16, 0xffff0000, v16
    v_and_b32 v20, 0xffff0000, v20
    v_and_b32 v72, 0xffff0000, v72
    v_and_b32 v76, 0xffff0000, v76
    v_and_b32 v80, 0xffff0000, v80
    v_and_b32 v84, 0xffff0000, v84
    v_mul_f32 v8, s63, v8
    v_mul_f32 v12, s63, v12
    v_mul_f32 v16, s63, v16
    v_mul_f32 v20, s63, v20
    v_mul_f32 v72, s63, v72
    v_mul_f32 v76, s63, v76
    v_mul_f32 v80, s63, v80
    v_mul_f32 v84, s63, v84
    v_cvt_pk_bf16_f32 v8, v8, v8
    v_cvt_pk_bf16_f32 v12, v12, v12
    v_cvt_pk_bf16_f32 v16, v16, v16
    v_cvt_pk_bf16_f32 v20, v20, v20
    v_cvt_pk_bf16_f32 v72, v72, v72
    v_cvt_pk_bf16_f32 v76, v76, v76
    v_cvt_pk_bf16_f32 v80, v80, v80
    v_cvt_pk_bf16_f32 v84, v84, v84
    v_and_b32 v8, 0xffff0000, v8
    v_and_b32 v12, 0xffff0000, v12
    v_and_b32 v16, 0xffff0000, v16
    v_and_b32 v20, 0xffff0000, v20
    v_and_b32 v72, 0xffff0000, v72
    v_and_b32 v76, 0xffff0000, v76
    v_and_b32 v80, 0xffff0000, v80
    v_and_b32 v84, 0xffff0000, v84
    v_max3_f32 v140, v8, v12, v16
    v_max3_f32 v141, v20, v72, v76
    v_max3_f32 v140, v140, v80, v84
    v_max_f32 v140, v140, v141
    s_nop 1
    v_max_f32_dpp v140, v140, v140 row_ror:4 row_mask:0xf bank_mask:0xf
    s_nop 1
    v_max_f32_dpp v140, v140, v140 row_ror:8 row_mask:0xf bank_mask:0xf
    v_mov_b32 v141, v140
    s_nop 1
    v_permlane16_swap_b32 v140, v141
    v_max_f32 v140, v140, v141
    v_mov_b32 v141, v140
    s_nop 1
    v_permlane32_swap_b32 v140, v141
    v_max_f32 v140, v140, v141
    s_mov_b32 s63, 1069066811
    v_sub_f32 v8, v8, v140
    v_sub_f32 v12, v12, v140
    v_sub_f32 v16, v16, v140
    v_sub_f32 v20, v20, v140
    v_sub_f32 v72, v72, v140
    v_sub_f32 v76, v76, v140
    v_sub_f32 v80, v80, v140
    v_sub_f32 v84, v84, v140
    v_mul_f32 v8, s63, v8
    v_mul_f32 v12, s63, v12
    v_mul_f32 v16, s63, v16
    v_mul_f32 v20, s63, v20
    v_mul_f32 v72, s63, v72
    v_mul_f32 v76, s63, v76
    v_mul_f32 v80, s63, v80
    v_mul_f32 v84, s63, v84
    v_exp_f32 v8, v8
    v_exp_f32 v12, v12
    v_exp_f32 v16, v16
    v_exp_f32 v20, v20
    v_exp_f32 v72, v72
    v_exp_f32 v76, v76
    v_exp_f32 v80, v80
    v_exp_f32 v84, v84
    v_add_f32 v142, v8, v12
    v_add_f32 v143, v16, v20
    v_add_f32 v144, v72, v76
    v_add_f32 v145, v80, v84
    v_add_f32 v142, v142, v143
    v_add_f32 v144, v144, v145
    v_add_f32 v142, v142, v144
    s_nop 1
    v_add_f32_dpp v142, v142, v142 row_ror:4 row_mask:0xf bank_mask:0xf
    s_nop 1
    v_add_f32_dpp v142, v142, v142 row_ror:8 row_mask:0xf bank_mask:0xf
    v_mov_b32 v143, v142
    s_nop 1
    v_permlane16_swap_b32 v142, v143
    v_add_f32 v142, v142, v143
    v_mov_b32 v143, v142
    s_nop 1
    v_permlane32_swap_b32 v142, v143
    v_add_f32 v142, v142, v143
    v_cvt_pk_bf16_f32 v8, v8, v8
    v_cvt_pk_bf16_f32 v12, v12, v12
    v_cvt_pk_bf16_f32 v16, v16, v16
    v_cvt_pk_bf16_f32 v20, v20, v20
    v_cvt_pk_bf16_f32 v72, v72, v72
    v_cvt_pk_bf16_f32 v76, v76, v76
    v_cvt_pk_bf16_f32 v80, v80, v80
    v_cvt_pk_bf16_f32 v84, v84, v84
    v_lshrrev_b32 v144, 4, v0
    v_lshlrev_b32 v144, 7, v144
    v_bfe_u32 v145, v0, 2, 2
    v_lshl_add_u32 v144, v145, 4, v144
    s_lshl_b32 s63, s59, 9
    v_add_u32 v144, s63, v144
    ds_write_b32 v144, v8 offset:2048
    ds_write_b32 v144, v12 offset:2052
    ds_write_b32 v144, v16 offset:2056
    ds_write_b32 v144, v20 offset:2060
    ds_write_b32 v144, v72 offset:2112
    ds_write_b32 v144, v76 offset:2116
    ds_write_b32 v144, v80 offset:2120
    ds_write_b32 v144, v84 offset:2124
    s_lshl_b32 s63, s59, 2
    v_mov_b32 v145, s63
    ds_write_b32 v145, v140 offset:512
    ds_write_b32 v145, v142 offset:528
    ds_write_b32 v145, v2 offset:16
    v_lshrrev_b32 v136, 4, v0
    v_bfe_u32 v149, v0, 2, 2
    v_lshl_add_u32 v136, v136, 3, v149
    v_lshlrev_b32 v136, 7, v136
    v_and_b32 v149, 3, v0
    v_lshl_add_u32 v136, v149, 3, v136
    v_add_u32 v136, 40960, v136
    s_lshl_b32 s63, s59, 5
    v_add_u32 v136, s63, v136
    v_lshrrev_b32 v137, 4, v0
    v_bfe_u32 v149, v0, 2, 2
    v_lshl_add_u32 v137, v137, 3, v149
    v_lshlrev_b32 v137, 9, v137
    v_and_b32 v149, 3, v0
    v_lshl_add_u32 v137, v149, 3, v137
    v_add_u32 v137, 57344, v137
    s_mul_i32 s63, s59, 96
    v_add_u32 v137, s63, v137
    v_lshrrev_b32 v148, 4, v0
    v_bfe_u32 v149, v0, 2, 2
    v_lshl_add_u32 v148, v148, 3, v149
    v_lshlrev_b32 v148, 8, v148
    v_and_b32 v149, 3, v0
    v_lshl_add_u32 v148, v149, 3, v148
    v_add_u32 v148, 73728, v148
    s_lshl_b32 s63, s59, 6
    v_add_u32 v148, s63, v148
    v_lshrrev_b32 v138, 4, v0
    v_lshlrev_b32 v138, 4, v138
    v_and_b32 v149, 1, v0
    v_lshl_add_u32 v150, v149, 6, v138
    s_mul_i32 s63, s59, 192
    s_add_u32 s63, s63, s74
    s_add_u32 s63, s63, 2048
    v_mul_u32_u24 v151, 768, v149
    v_add_u32 v151, v151, v138
    v_add_u32 v151, s63, v151
    s_mov_b32 s66, 0x30003
    s_mov_b32 s67, 0x30003
    s_mov_b32 s68, 2097152
L_spin_3:
    ds_read_b64 v[84:85], v3 offset:112
    s_waitcnt lgkmcnt(0)
    v_cmp_ne_u32 vcc, v84, v2
    s_cbranch_vccz L_spinx_4
    s_sleep 2
    s_sub_u32 s68, s68, 1
    s_cbranch_scc0 L_spin_3
L_spinx_4:
    v_readfirstlane_b32 s69, v85
    s_lshl_b32 s63, s4, 11
    s_lshl_b32 s64, s5, 8
    s_add_u32 s63, s63, s64
    s_lshl_b32 s64, s59, 6
    s_add_u32 s63, s63, s64
    s_add_u32 s63, s63, 131072
    v_add_u32 v139, s63, v138
    s_mul_i32 s63, s59, 192
    s_add_u32 s63, s63, s74
    s_add_u32 s64, s63, 1024
    v_add_u32 v146, s64, v138
    s_lshr_b32 s63, s88, 2
    s_add_u32 s63, s63, s90
    s_lshl_b32 s63, s63, 11
    s_and_b32 s64, s88, 3
    s_lshl_b32 s64, s64, 9
    s_add_u32 s63, s63, s64
    s_lshl_b32 s64, s59, 7
    s_add_u32 s63, s63, s64
    s_add_u32 s63, s63, 196608
    v_add_u32 v147, s63, v138
    s_lshl_b32 s65, s89, 2
    s_mov_b64 s[56:57], 0
    s_mov_b64 exec, 0
    s_branch L_ktail
L_ktail_ret:
    s_mov_b64 s[56:57], -1
    s_mov_b64 exec, -1
L_ktail:
    s_mov_b32 s68, 2097152
L_spin_5:
    ds_read_b32 v84, v3 offset:64
    s_waitcnt lgkmcnt(0)
    v_cmp_ne_u32 vcc, v84, v2
    s_cbranch_vccz L_spinx_6
    s_sleep 1
    s_sub_u32 s68, s68, 1
    s_cbranch_scc0 L_spin_5
L_spinx_6:
    ds_read_b64_tr_b16 v[8:9], v136 offset:0
    ds_read_b64_tr_b16 v[10:11], v136 offset:512
    ds_read_b64_tr_b16 v[12:13], v136 offset:4096
    ds_read_b64_tr_b16 v[14:15], v136 offset:4608
    ds_read_b64_tr_b16 v[16:17], v136 offset:8192
    ds_read_b64_tr_b16 v[18:19], v136 offset:8704
    ds_read_b64_tr_b16 v[20:21], v136 offset:12288
    ds_read_b64_tr_b16 v[22:23], v136 offset:12800
    s_waitcnt lgkmcnt(0)
    s_mov_b32 s68, 2097152
L_spin_7:
    ds_read_b32 v84, v3 offset:80
    ds_read_b128 v[48:51], v138 offset:1280
    ds_read_b128 v[52:55], v138 offset:1344
    ds_read_b128 v[56:59], v138 offset:1408
    ds_read_b128 v[60:63], v138 offset:1472
    s_waitcnt lgkmcnt(0)
    v_cmp_ne_u32 vcc, v84, v2
    s_cbranch_vccz L_spinx_8
    s_sub_u32 s68, s68, 1
    s_cbranch_scc0 L_spin_7
L_spinx_8:
    v_mfma_f32_16x16x32_bf16 v[64:67], v[8:11], v[48:51], 0
    v_mfma_f32_16x16x32_bf16 v[64:67], v[12:15], v[52:55], v[64:67]
    v_mfma_f32_16x16x32_bf16 v[64:67], v[16:19], v[56:59], v[64:67]
    v_mfma_f32_16x16x32_bf16 v[64:67], v[20:23], v[60:63], v[64:67]
    s_and_b64 exec, s[56:57], s[94:95]
    s_nop 6
    buffer_store_dwordx4 v[64:67], v139, s[36:39], 0 offen sc1
    s_mov_b64 exec, s[56:57]
    s_mov_b32 s68, 2097152
L_spin_9:
    ds_read_b32 v84, v3 offset:68
    s_waitcnt lgkmcnt(0)
    v_cmp_ne_u32 vcc, v84, v2
    s_cbranch_vccz L_spinx_10
    s_sub_u32 s68, s68, 1
    s_cbranch_scc0 L_spin_9
L_spinx_10:
    ds_read_b64_tr_b16 v[152:153], v137 offset:0
    ds_read_b64_tr_b16 v[154:155], v137 offset:2048
    ds_read_b64_tr_b16 v[156:157], v137 offset:32
    ds_read_b64_tr_b16 v[158:159], v137 offset:2080
    ds_read_b64_tr_b16 v[160:161], v137 offset:64
    ds_read_b64_tr_b16 v[162:163], v137 offset:2112
    ds_read_b128 v[48:51], v150 offset:1728
    s_waitcnt lgkmcnt(0)
    v_mfma_f32_16x16x32_bf16 v[64:67], v[152:155], v[48:51], 0
    v_mfma_f32_16x16x32_bf16 v[68:71], v[156:159], v[48:51], 0
    v_mfma_f32_16x16x32_bf16 v[72:75], v[160:163], v[48:51], 0
    s_and_b64 exec, s[56:57], s[66:67]
    s_cmp_lg_u32 s69, 0
    s_cbranch_scc0 L_pg_11
    s_nop 2
    buffer_store_dwordx4 v[64:67], v151, s[36:39], s96 offen
    buffer_store_dwordx4 v[68:71], v151, s[36:39], s96 offen offset:64
    buffer_store_dwordx4 v[72:75], v151, s[36:39], s96 offen offset:128
L_pd_12:
    s_mov_b64 exec, s[56:57]
    s_mov_b32 s68, 2097152
L_spin_13:
    ds_read_b32 v84, v3 offset:84
    ds_read_b128 v[48:51], v138 offset:1536
    ds_read_b128 v[52:55], v138 offset:1600
    s_waitcnt lgkmcnt(0)
    v_cmp_ne_u32 vcc, v84, v2
    s_cbranch_vccz L_spinx_14
    s_sub_u32 s68, s68, 1
    s_cbranch_scc0 L_spin_13
L_spinx_14:
    v_mfma_f32_16x16x32_bf16 v[64:67], v[152:155], v[48:51], 0
    v_mfma_f32_16x16x32_bf16 v[68:71], v[156:159], v[48:51], 0
    v_mfma_f32_16x16x32_bf16 v[72:75], v[160:163], v[48:51], 0
    v_mfma_f32_16x16x32_bf16 v[64:67], v[152:155], v[52:55], v[64:67]
    v_mfma_f32_16x16x32_bf16 v[68:71], v[156:159], v[52:55], v[68:71]
    v_mfma_f32_16x16x32_bf16 v[72:75], v[160:163], v[52:55], v[72:75]
    s_and_b64 exec, s[56:57], s[94:95]
    s_cmp_lg_u32 s69, 0
    s_cbranch_scc0 L_pg_15
    s_nop 2
    buffer_store_dwordx4 v[64:67], v146, s[36:39], s96 offen
    buffer_store_dwordx4 v[68:71], v146, s[36:39], s96 offen offset:64
    buffer_store_dwordx4 v[72:75], v146, s[36:39], s96 offen offset:128
L_pd_16:
    s_mov_b64 exec, s[56:57]
    s_cmp_ge_u32 s88, s65
    s_cbranch_scc1 L_ktail_end
    s_mov_b32 s68, 2097152
L_spin_17:
    ds_read_b32 v84, v3 offset:72
    s_waitcnt lgkmcnt(0)
    v_cmp_ne_u32 vcc, v84, v2
    s_cbranch_vccz L_spinx_18
    s_sub_u32 s68, s68, 1
    s_cbranch_scc0 L_spin_17
L_spinx_18:
    ds_read_b64_tr_b16 v[40:41], v148 offset:0
    ds_read_b64_tr_b16 v[42:43], v148 offset:1024
    ds_read_b64_tr_b16 v[44:45], v148 offset:32
    ds_read_b64_tr_b16 v[46:47], v148 offset:1056
    s_mov_b32 s68, 2097152
L_spin_19:
    ds_read_b32 v84, v3 offset:88
    ds_read_b128 v[48:51], v138 offset:1664
    s_waitcnt lgkmcnt(0)
    v_cmp_ne_u32 vcc, v84, v2
    s_cbranch_vccz L_spinx_20
    s_sub_u32 s68, s68, 1
    s_cbranch_scc0 L_spin_19
L_spinx_20:
    v_mfma_f32_16x16x32_bf16 v[80:83], v[40:43], v[48:51], 0
    v_mfma_f32_16x16x32_bf16 v[84:87], v[44:47], v[48:51], 0
    s_and_b64 exec, s[56:57], s[94:95]
    s_nop 5
    buffer_store_dwordx4 v[80:83], v147, s[36:39], 0 offen offset:0 sc1
    buffer_store_dwordx4 v[84:87], v147, s[36:39], 0 offen offset:64 sc1
    s_mov_b64 exec, s[56:57]
L_ktail_end:
    s_cbranch_execz L_ktail_ret
    s_endpgm
L_vwave0:
    s_barrier
    s_cmp_lg_u32 s59, 0
    s_cbranch_scc1 L_v_noinit
    v_mov_b32 v4, -1
    v_mov_b32 v5, -1
    v_mov_b32 v6, -1
    v_mov_b32 v7, -1
    v_add_u32 v136, s74, v1
    buffer_store_dwordx4 v[4:7], v136, s[36:39], s96 offen offset:0
    buffer_store_dwordx4 v[4:7], v136, s[36:39], s96 offen offset:1024
    buffer_store_dwordx4 v[4:7], v136, s[36:39], s96 offen offset:2048
    buffer_store_dwordx4 v[4:7], v136, s[36:39], s96 offen offset:3072
    s_waitcnt lgkmcnt(0)
    s_mul_i32 s6, s6, 0x9E3779B1
    s_add_u32 s6, s6, 0x7F4A7C15
    s_or_b32 s6, s6, 1
    v_mov_b32 v2, s6
    v_mov_b32 v3, 0
    s_getreg_b32 s91, hwreg(HW_REG_XCC_ID)
    s_lshl_b32 s58, s75, 3
    s_add_u32 s58, s58, 8192
    v_mov_b32 v138, s58
    v_mov_b32 v140, s91
    v_mov_b32 v141, v2
    s_waitcnt vmcnt(0)
    s_mov_b64 exec, 1
    buffer_store_dwordx2 v[140:141], v138, s[36:39], 0 offen sc1
    s_mov_b64 exec, -1
    s_lshl_b32 s63, s4, 11
    s_lshl_b32 s64, s5, 8
    s_add_u32 s63, s63, s64
    s_add_u32 s63, s63, 131072
    v_add_u32 v137, s63, v1
    s_mov_b64 exec, 0xffff
    buffer_store_dwordx4 v[4:7], v137, s[36:39], 0 offen sc1
    s_lshl_b32 s65, s89, 2
    s_cmp_ge_u32 s88, s65
    s_cbranch_scc1 L_v_nozp
    s_lshr_b32 s63, s88, 2
    s_add_u32 s63, s63, s90
    s_lshl_b32 s63, s63, 11
    s_and_b32 s64, s88, 3
    s_lshl_b32 s64, s64, 9
    s_add_u32 s63, s63, s64
    s_add_u32 s63, s63, 196608
    s_mov_b32 exec_lo, -1
    v_add_u32 v137, s63, v1
    buffer_store_dwordx4 v[4:7], v137, s[36:39], 0 offen sc1
L_v_nozp:
    s_mov_b64 exec, 1
    s_waitcnt vmcnt(0)
    buffer_store_dwordx2 v[140:141], v138, s[36:39], 0 offen offset:2048 sc1
    s_mov_b64 exec, -1
    s_waitcnt vmcnt(0)
    s_branch L_v_go
L_v_noinit:
    s_waitcnt lgkmcnt(0)
    s_mul_i32 s6, s6, 0x9E3779B1
    s_add_u32 s6, s6, 0x7F4A7C15
    s_or_b32 s6, s6, 1
    v_mov_b32 v2, s6
    v_mov_b32 v3, 0
L_v_go:
    s_waitcnt vmcnt(0)
    s_mov_b32 s68, 2097152
L_spin_21:
    ds_read_b128 v[4:7], v3 offset:96
    s_waitcnt lgkmcnt(0)
    v_xor_b32 v136, v4, v2
    v_bitop3_b32 v136, v136, v5, v2 bitop3:0xf6
    v_bitop3_b32 v136, v136, v6, v2 bitop3:0xf6
    v_bitop3_b32 v136, v136, v7, v2 bitop3:0xf6
    v_cmp_ne_u32 vcc, 0, v136
    s_cbranch_vccz L_spinx_22
    s_sleep 2
    s_sub_u32 s68, s68, 1
    s_cbranch_scc0 L_spin_21
L_spinx_22:
    s_lshl_b32 s63, s59, 2
    v_mov_b32 v160, s63
    s_mov_b32 s62, 0
    buffer_load_dwordx4 v[8:11], v1, s[40:43], s62 offen offset:0 nt
    buffer_load_dwordx4 v[12:15], v1, s[40:43], s62 offen offset:1024 nt
    buffer_load_dwordx4 v[16:19], v1, s[40:43], s62 offen offset:2048 nt
    buffer_load_dwordx4 v[20:23], v1, s[40:43], s62 offen offset:3072 nt
    s_movk_i32 s62, 4096
    s_waitcnt vmcnt(3)
    buffer_load_dwordx4 v[24:27], v1, s[40:43], s62 offen offset:0 nt
    s_waitcnt vmcnt(3)
    buffer_load_dwordx4 v[28:31], v1, s[40:43], s62 offen offset:1024 nt
    s_waitcnt vmcnt(3)
    buffer_load_dwordx4 v[32:35], v1, s[40:43], s62 offen offset:2048 nt
    s_waitcnt vmcnt(3)
    buffer_load_dwordx4 v[36:39], v1, s[40:43], s62 offen offset:3072 nt
    s_movk_i32 s62, 8192
    buffer_load_dwordx4 v[40:43], v1, s[40:43], s62 offen offset:0 nt
    buffer_load_dwordx4 v[44:47], v1, s[40:43], s62 offen offset:1024 nt
    s_waitcnt vmcnt(9)
    buffer_load_dwordx4 v[48:51], v1, s[40:43], s62 offen offset:2048 nt
    s_waitcnt vmcnt(9)
    buffer_load_dwordx4 v[52:55], v1, s[40:43], s62 offen offset:3072 nt
    s_movk_i32 s62, 12288
    s_waitcnt vmcnt(9)
    buffer_load_dwordx4 v[56:59], v1, s[40:43], s62 offen offset:0 nt
    s_waitcnt vmcnt(9)
    buffer_load_dwordx4 v[60:63], v1, s[40:43], s62 offen offset:1024 nt
    s_waitcnt vmcnt(9)
    buffer_load_dwordx4 v[64:67], v1, s[40:43], s62 offen offset:2048 nt
    s_waitcnt vmcnt(9)
    buffer_load_dwordx4 v[68:71], v1, s[40:43], s62 offen offset:3072 nt
    s_movk_i32 s62, 16384
    s_waitcnt vmcnt(15)
    buffer_load_dwordx4 v[72:75], v1, s[40:43], s62 offen offset:0 nt
    s_waitcnt vmcnt(15)
    buffer_load_dwordx4 v[76:79], v1, s[40:43], s62 offen offset:1024 nt
    s_waitcnt vmcnt(15)
    buffer_load_dwordx4 v[80:83], v1, s[40:43], s62 offen offset:2048 nt
    s_waitcnt vmcnt(15)
    buffer_load_dwordx4 v[84:87], v1, s[40:43], s62 offen offset:3072 nt
    s_movk_i32 s62, 20480
    s_waitcnt vmcnt(15)
    buffer_load_dwordx4 v[88:91], v1, s[40:43], s62 offen offset:0 nt
    s_waitcnt vmcnt(15)
    buffer_load_dwordx4 v[92:95], v1, s[40:43], s62 offen offset:1024 nt
    s_waitcnt vmcnt(15)
    buffer_load_dwordx4 v[96:99], v1, s[40:43], s62 offen offset:2048 nt
    s_waitcnt vmcnt(15)
    buffer_load_dwordx4 v[100:103], v1, s[40:43], s62 offen offset:3072 nt
    s_movk_i32 s62, 24576
    s_waitcnt vmcnt(15)
    buffer_load_dwordx4 v[104:107], v1, s[40:43], s62 offen offset:0 nt
    s_waitcnt vmcnt(15)
    buffer_load_dwordx4 v[108:111], v1, s[40:43], s62 offen offset:1024 nt
    s_waitcnt vmcnt(15)
    buffer_load_dwordx4 v[112:115], v1, s[40:43], s62 offen offset:2048 nt
    s_waitcnt vmcnt(15)
    buffer_load_dwordx4 v[116:119], v1, s[40:43], s62 offen offset:3072 nt
    s_movk_i32 s62, 28672
    s_waitcnt vmcnt(15)
    buffer_load_dwordx4 v[120:123], v1, s[40:43], s62 offen offset:0 nt
    s_waitcnt vmcnt(15)
    buffer_load_dwordx4 v[124:127], v1, s[40:43], s62 offen offset:1024 nt
    s_waitcnt vmcnt(15)
    buffer_load_dwordx4 v[128:131], v1, s[40:43], s62 offen offset:2048 nt
    s_waitcnt vmcnt(15)
    buffer_load_dwordx4 v[132:135], v1, s[40:43], s62 offen offset:3072 nt
    ds_write_b32 v160, v2 offset:48
    v_and_b32 v161, 15, v0
    v_lshrrev_b32 v162, 1, v161
    v_and_b32 v161, 1, v161
    v_cmp_eq_u32 vcc, 1, v161
    v_mov_b32 v163, 0xffff
    v_mov_b32 v161, 0xffff0000
    v_cndmask_b32 v163, v163, v161, vcc
    v_cmp_eq_u32 vcc, 0, v162
    s_nop 1
    v_cndmask_b32 v136, 0, v163, vcc
    v_cmp_eq_u32 vcc, 1, v162
    s_nop 1
    v_cndmask_b32 v137, 0, v163, vcc
    v_cmp_eq_u32 vcc, 2, v162
    s_nop 1
    v_cndmask_b32 v138, 0, v163, vcc
    v_cmp_eq_u32 vcc, 3, v162
    s_nop 1
    v_cndmask_b32 v139, 0, v163, vcc
    v_lshrrev_b32 v161, 4, v0
    v_lshlrev_b32 v161, 7, v161
    s_lshl_b32 s63, s59, 9
    v_add_u32 v161, s63, v161
    s_mov_b32 s68, 2097152
L_spin_23:
    ds_read_b32 v162, v160 offset:16
    ds_read_b128 v[148:151], v161 offset:2048
    s_waitcnt lgkmcnt(0)
    v_cmp_ne_u32 vcc, v162, v2
    s_cbranch_vccz L_spinx_24
    s_sleep 2
    s_sub_u32 s68, s68, 1
    s_cbranch_scc0 L_spin_23
L_spinx_24:
    v_and_b32 v162, 15, v0
    v_lshlrev_b32 v162, 5, v162
    v_lshrrev_b32 v163, 4, v0
    v_lshl_add_u32 v162, v163, 4, v162
    s_lshl_b32 s63, s59, 9
    v_add_u32 v162, s63, v162
    ds_read_b128 v[152:155], v161 offset:2064
    v_and_b32 v140, v148, v136
    v_and_b32 v141, v148, v137
    v_and_b32 v142, v148, v138
    v_and_b32 v143, v148, v139
    s_waitcnt vmcnt(31)
    s_nop 0
    v_mfma_f32_16x16x32_bf16 v[156:159], v[140:143], v[8:11], 0
    v_and_b32 v144, v149, v136
    v_and_b32 v145, v149, v137
    v_and_b32 v146, v149, v138
    v_and_b32 v147, v149, v139
    s_waitcnt vmcnt(30)
    s_nop 0
    v_mfma_f32_16x16x32_bf16 v[156:159], v[144:147], v[12:15], v[156:159]
    v_and_b32 v140, v150, v136
    v_and_b32 v141, v150, v137
    v_and_b32 v142, v150, v138
    v_and_b32 v143, v150, v139
    s_waitcnt vmcnt(29)
    s_nop 0
    v_mfma_f32_16x16x32_bf16 v[156:159], v[140:143], v[16:19], v[156:159]
    v_and_b32 v144, v151, v136
    v_and_b32 v145, v151, v137
    v_and_b32 v146, v151, v138
    v_and_b32 v147, v151, v139
    s_waitcnt vmcnt(28)
    s_nop 0
    v_mfma_f32_16x16x32_bf16 v[156:159], v[144:147], v[20:23], v[156:159]
    s_waitcnt lgkmcnt(0)
    ds_read_b128 v[148:151], v161 offset:2080
    v_and_b32 v140, v152, v136
    v_and_b32 v141, v152, v137
    v_and_b32 v142, v152, v138
    v_and_b32 v143, v152, v139
    s_waitcnt vmcnt(27)
    s_nop 0
    v_mfma_f32_16x16x32_bf16 v[156:159], v[140:143], v[24:27], v[156:159]
    v_and_b32 v144, v153, v136
    v_and_b32 v145, v153, v137
    v_and_b32 v146, v153, v138
    v_and_b32 v147, v153, v139
    s_waitcnt vmcnt(26)
    s_nop 0
    v_mfma_f32_16x16x32_bf16 v[156:159], v[144:147], v[28:31], v[156:159]
    v_and_b32 v140, v154, v136
    v_and_b32 v141, v154, v137
    v_and_b32 v142, v154, v138
    v_and_b32 v143, v154, v139
    s_waitcnt vmcnt(25)
    s_nop 0
    v_mfma_f32_16x16x32_bf16 v[156:159], v[140:143], v[32:35], v[156:159]
    v_and_b32 v144, v155, v136
    v_and_b32 v145, v155, v137
    v_and_b32 v146, v155, v138
    v_and_b32 v147, v155, v139
    s_waitcnt vmcnt(24)
    s_nop 0
    v_mfma_f32_16x16x32_bf16 v[156:159], v[144:147], v[36:39], v[156:159]
    s_waitcnt lgkmcnt(0)
    ds_read_b128 v[152:155], v161 offset:2096
    v_and_b32 v140, v148, v136
    v_and_b32 v141, v148, v137
    v_and_b32 v142, v148, v138
    v_and_b32 v143, v148, v139
    s_waitcnt vmcnt(23)
    s_nop 0
    v_mfma_f32_16x16x32_bf16 v[156:159], v[140:143], v[40:43], v[156:159]
    v_and_b32 v144, v149, v136
    v_and_b32 v145, v149, v137
    v_and_b32 v146, v149, v138
    v_and_b32 v147, v149, v139
    s_waitcnt vmcnt(22)
    s_nop 0
    v_mfma_f32_16x16x32_bf16 v[156:159], v[144:147], v[44:47], v[156:159]
    v_and_b32 v140, v150, v136
    v_and_b32 v141, v150, v137
    v_and_b32 v142, v150, v138
    v_and_b32 v143, v150, v139
    s_waitcnt vmcnt(21)
    s_nop 0
    v_mfma_f32_16x16x32_bf16 v[156:159], v[140:143], v[48:51], v[156:159]
    v_and_b32 v144, v151, v136
    v_and_b32 v145, v151, v137
    v_and_b32 v146, v151, v138
    v_and_b32 v147, v151, v139
    s_waitcnt vmcnt(20)
    s_nop 0
    v_mfma_f32_16x16x32_bf16 v[156:159], v[144:147], v[52:55], v[156:159]
    s_waitcnt lgkmcnt(0)
    ds_read_b128 v[148:151], v161 offset:2112
    v_and_b32 v140, v152, v136
    v_and_b32 v141, v152, v137
    v_and_b32 v142, v152, v138
    v_and_b32 v143, v152, v139
    s_waitcnt vmcnt(19)
    s_nop 0
    v_mfma_f32_16x16x32_bf16 v[156:159], v[140:143], v[56:59], v[156:159]
    v_and_b32 v144, v153, v136
    v_and_b32 v145, v153, v137
    v_and_b32 v146, v153, v138
    v_and_b32 v147, v153, v139
    s_waitcnt vmcnt(18)
    s_nop 0
    v_mfma_f32_16x16x32_bf16 v[156:159], v[144:147], v[60:63], v[156:159]
    v_and_b32 v140, v154, v136
    v_and_b32 v141, v154, v137
    v_and_b32 v142, v154, v138
    v_and_b32 v143, v154, v139
    s_waitcnt vmcnt(17)
    s_nop 0
    v_mfma_f32_16x16x32_bf16 v[156:159], v[140:143], v[64:67], v[156:159]
    v_and_b32 v144, v155, v136
    v_and_b32 v145, v155, v137
    v_and_b32 v146, v155, v138
    v_and_b32 v147, v155, v139
    s_waitcnt vmcnt(16)
    s_nop 0
    v_mfma_f32_16x16x32_bf16 v[156:159], v[144:147], v[68:71], v[156:159]
    s_waitcnt lgkmcnt(0)
    ds_read_b128 v[152:155], v161 offset:2128
    v_and_b32 v140, v148, v136
    v_and_b32 v141, v148, v137
    v_and_b32 v142, v148, v138
    v_and_b32 v143, v148, v139
    s_waitcnt vmcnt(15)
    s_nop 0
    v_mfma_f32_16x16x32_bf16 v[156:159], v[140:143], v[72:75], v[156:159]
    v_and_b32 v144, v149, v136
    v_and_b32 v145, v149, v137
    v_and_b32 v146, v149, v138
    v_and_b32 v147, v149, v139
    s_waitcnt vmcnt(14)
    s_nop 0
    v_mfma_f32_16x16x32_bf16 v[156:159], v[144:147], v[76:79], v[156:159]
    v_and_b32 v140, v150, v136
    v_and_b32 v141, v150, v137
    v_and_b32 v142, v150, v138
    v_and_b32 v143, v150, v139
    s_waitcnt vmcnt(13)
    s_nop 0
    v_mfma_f32_16x16x32_bf16 v[156:159], v[140:143], v[80:83], v[156:159]
    v_and_b32 v144, v151, v136
    v_and_b32 v145, v151, v137
    v_and_b32 v146, v151, v138
    v_and_b32 v147, v151, v139
    s_waitcnt vmcnt(12)
    s_nop 0
    v_mfma_f32_16x16x32_bf16 v[156:159], v[144:147], v[84:87], v[156:159]
    s_waitcnt lgkmcnt(0)
    ds_read_b128 v[148:151], v161 offset:2144
    v_and_b32 v140, v152, v136
    v_and_b32 v141, v152, v137
    v_and_b32 v142, v152, v138
    v_and_b32 v143, v152, v139
    s_waitcnt vmcnt(11)
    s_nop 0
    v_mfma_f32_16x16x32_bf16 v[156:159], v[140:143], v[88:91], v[156:159]
    v_and_b32 v144, v153, v136
    v_and_b32 v145, v153, v137
    v_and_b32 v146, v153, v138
    v_and_b32 v147, v153, v139
    s_waitcnt vmcnt(10)
    s_nop 0
    v_mfma_f32_16x16x32_bf16 v[156:159], v[144:147], v[92:95], v[156:159]
    v_and_b32 v140, v154, v136
    v_and_b32 v141, v154, v137
    v_and_b32 v142, v154, v138
    v_and_b32 v143, v154, v139
    s_waitcnt vmcnt(9)
    s_nop 0
    v_mfma_f32_16x16x32_bf16 v[156:159], v[140:143], v[96:99], v[156:159]
    v_and_b32 v144, v155, v136
    v_and_b32 v145, v155, v137
    v_and_b32 v146, v155, v138
    v_and_b32 v147, v155, v139
    s_waitcnt vmcnt(8)
    s_nop 0
    v_mfma_f32_16x16x32_bf16 v[156:159], v[144:147], v[100:103], v[156:159]
    s_waitcnt lgkmcnt(0)
    ds_read_b128 v[152:155], v161 offset:2160
    v_and_b32 v140, v148, v136
    v_and_b32 v141, v148, v137
    v_and_b32 v142, v148, v138
    v_and_b32 v143, v148, v139
    s_waitcnt vmcnt(7)
    s_nop 0
    v_mfma_f32_16x16x32_bf16 v[156:159], v[140:143], v[104:107], v[156:159]
    v_and_b32 v144, v149, v136
    v_and_b32 v145, v149, v137
    v_and_b32 v146, v149, v138
    v_and_b32 v147, v149, v139
    s_waitcnt vmcnt(6)
    s_nop 0
    v_mfma_f32_16x16x32_bf16 v[156:159], v[144:147], v[108:111], v[156:159]
    v_and_b32 v140, v150, v136
    v_and_b32 v141, v150, v137
    v_and_b32 v142, v150, v138
    v_and_b32 v143, v150, v139
    s_waitcnt vmcnt(5)
    s_nop 0
    v_mfma_f32_16x16x32_bf16 v[156:159], v[140:143], v[112:115], v[156:159]
    v_and_b32 v144, v151, v136
    v_and_b32 v145, v151, v137
    v_and_b32 v146, v151, v138
    v_and_b32 v147, v151, v139
    s_waitcnt vmcnt(4)
    s_nop 0
    v_mfma_f32_16x16x32_bf16 v[156:159], v[144:147], v[116:119], v[156:159]
    s_waitcnt lgkmcnt(0)
    v_and_b32 v140, v152, v136
    v_and_b32 v141, v152, v137
    v_and_b32 v142, v152, v138
    v_and_b32 v143, v152, v139
    s_waitcnt vmcnt(3)
    s_nop 0
    v_mfma_f32_16x16x32_bf16 v[156:159], v[140:143], v[120:123], v[156:159]
    v_and_b32 v144, v153, v136
    v_and_b32 v145, v153, v137
    v_and_b32 v146, v153, v138
    v_and_b32 v147, v153, v139
    s_waitcnt vmcnt(2)
    s_nop 0
    v_mfma_f32_16x16x32_bf16 v[156:159], v[144:147], v[124:127], v[156:159]
    v_and_b32 v140, v154, v136
    v_and_b32 v141, v154, v137
    v_and_b32 v142, v154, v138
    v_and_b32 v143, v154, v139
    s_waitcnt vmcnt(1)
    s_nop 0
    v_mfma_f32_16x16x32_bf16 v[156:159], v[140:143], v[128:131], v[156:159]
    v_and_b32 v144, v155, v136
    v_and_b32 v145, v155, v137
    v_and_b32 v146, v155, v138
    v_and_b32 v147, v155, v139
    s_waitcnt vmcnt(0)
    s_nop 0
    v_mfma_f32_16x16x32_bf16 v[156:159], v[144:147], v[132:135], v[156:159]
    s_mov_b32 exec_hi, 0
    s_nop 6
    ds_write_b128 v162, v[156:159] offset:4096
    ds_write_b32 v160, v2 offset:32
    s_endpgm
L_helpers:
    s_cmp_eq_u32 s3, 1
    s_cbranch_scc1 L_gwave
    s_setprio 3
    v_mov_b32 v3, 0
    v_lshlrev_b32 v4, 2, v0
    ds_write_b32 v4, v3
    s_cmp_ge_u32 s2, 192
    s_cbranch_scc1 L_h0_nomod
    s_mov_b32 s40, s28
    s_and_b32 s41, s29, 0xffff
    s_mov_b32 s42, 3145728
    s_mov_b32 s43, 0x20000
    s_mov_b32 s44, s26
    s_and_b32 s45, s27, 0xffff
    s_mov_b32 s46, 1024
    s_mov_b32 s47, 0x20000
    s_cmp_lt_u32 s2, 64
    s_cbranch_scc1 L_h0_p1
    s_sub_u32 s58, s2, 64
    s_lshr_b32 s59, s58, 5
    s_and_b32 s60, s58, 31
    s_add_u32 s60, s60, 16
    s_branch L_h0_ids
L_h0_p1:
    s_lshr_b32 s59, s2, 4
    s_and_b32 s60, s2, 15
L_h0_ids:
    s_lshl_b32 s61, s59, 8
    v_lshl_add_u32 v4, v0, 2, s61
    buffer_load_dword v5, v4, s[44:47], 0 offen
    v_lshrrev_b32 v6, 3, v0
    v_mul_u32_u24 v6, 6144, v6
    v_and_b32 v7, 7, v0
    v_lshl_add_u32 v6, v7, 4, v6
    s_mul_i32 s62, s59, 786432
    s_lshl_b32 s63, s60, 7
    s_add_u32 s62, s62, s63
    s_mov_b32 m0, 8192
    s_nop 0
    buffer_load_dwordx4 v6, s[40:43], s62 offen nt lds
    s_add_u32 s62, s62, 49152
    s_mov_b32 m0, 9216
    s_nop 0
    buffer_load_dwordx4 v6, s[40:43], s62 offen nt lds
    s_add_u32 s62, s62, 49152
    s_mov_b32 m0, 10240
    s_nop 0
    buffer_load_dwordx4 v6, s[40:43], s62 offen nt lds
    s_add_u32 s62, s62, 49152
    s_mov_b32 m0, 11264
    s_nop 0
    buffer_load_dwordx4 v6, s[40:43], s62 offen nt lds
    s_add_u32 s62, s62, 49152
    s_mov_b32 m0, 12288
    s_nop 0
    buffer_load_dwordx4 v6, s[40:43], s62 offen nt lds
    s_add_u32 s62, s62, 49152
    s_mov_b32 m0, 13312
    s_nop 0
    buffer_load_dwordx4 v6, s[40:43], s62 offen nt lds
    s_add_u32 s62, s62, 49152
    s_mov_b32 m0, 14336
    s_nop 0
    buffer_load_dwordx4 v6, s[40:43], s62 offen nt lds
    s_add_u32 s62, s62, 49152
    s_mov_b32 m0, 15360
    s_nop 0
    buffer_load_dwordx4 v6, s[40:43], s62 offen nt lds
    s_add_u32 s62, s62, 49152
    s_mov_b32 m0, 16384
    s_nop 0
    buffer_load_dwordx4 v6, s[40:43], s62 offen nt lds
    s_add_u32 s62, s62, 49152
    s_mov_b32 m0, 17408
    s_nop 0
    buffer_load_dwordx4 v6, s[40:43], s62 offen nt lds
    s_add_u32 s62, s62, 49152
    s_mov_b32 m0, 18432
    s_nop 0
    buffer_load_dwordx4 v6, s[40:43], s62 offen nt lds
    s_add_u32 s62, s62, 49152
    s_mov_b32 m0, 19456
    s_nop 0
    buffer_load_dwordx4 v6, s[40:43], s62 offen nt lds
    s_add_u32 s62, s62, 49152
    s_mov_b32 m0, 20480
    s_nop 0
    buffer_load_dwordx4 v6, s[40:43], s62 offen nt lds
    s_add_u32 s62, s62, 49152
    s_mov_b32 m0, 21504
    s_nop 0
    buffer_load_dwordx4 v6, s[40:43], s62 offen nt lds
    s_add_u32 s62, s62, 49152
    s_mov_b32 m0, 22528
    s_nop 0
    buffer_load_dwordx4 v6, s[40:43], s62 offen nt lds
    s_add_u32 s62, s62, 49152
    s_mov_b32 m0, 23552
    s_nop 0
    buffer_load_dwordx4 v6, s[40:43], s62 offen nt lds
    s_setprio 1
    s_waitcnt lgkmcnt(0)
    s_barrier
    s_waitcnt lgkmcnt(0)
    s_mul_i32 s6, s6, 0x9E3779B1
    s_add_u32 s6, s6, 0x7F4A7C15
    s_or_b32 s6, s6, 1
    v_mov_b32 v2, s6
    v_mov_b32 v3, 0
    s_waitcnt vmcnt(16)
    v_lshlrev_b32 v8, 16, v5
    v_and_b32 v9, 0xffff0000, v5
    s_mov_b32 s63, 3216550459
    v_mul_f32 v10, s63, v8
    v_mul_f32 v11, s63, v9
    v_exp_f32 v10, v10
    v_exp_f32 v11, v11
    v_add_f32 v10, 1.0, v10
    v_add_f32 v11, 1.0, v11
    v_rcp_f32 v12, v10
    v_rcp_f32 v13, v11
    v_mul_f32 v14, v8, v12
    v_mul_f32 v15, v9, v13
    v_cvt_pk_bf16_f32 v8, v14, v15
    v_lshlrev_b32 v9, 2, v0
    ds_write_b32 v9, v8 offset:768
    v_lshrrev_b32 v10, 4, v0
    v_lshlrev_b32 v10, 4, v10
    ds_read_b128 v[16:19], v10 offset:768
    ds_read_b128 v[20:23], v10 offset:832
    ds_read_b128 v[24:27], v10 offset:896
    ds_read_b128 v[28:31], v10 offset:960
    v_lshrrev_b32 v11, 4, v0
    v_bfe_u32 v12, v0, 2, 2
    v_lshl_add_u32 v11, v11, 3, v12
    v_lshlrev_b32 v11, 7, v11
    v_and_b32 v12, 3, v0
    v_lshl_add_u32 v11, v12, 3, v11
    v_add_u32 v11, 8192, v11
    s_waitcnt vmcnt(0)
    ds_read_b64_tr_b16 v[32:33], v11 offset:0
    ds_read_b64_tr_b16 v[34:35], v11 offset:512
    ds_read_b64_tr_b16 v[36:37], v11 offset:32
    ds_read_b64_tr_b16 v[38:39], v11 offset:544
    ds_read_b64_tr_b16 v[40:41], v11 offset:64
    ds_read_b64_tr_b16 v[42:43], v11 offset:576
    ds_read_b64_tr_b16 v[44:45], v11 offset:96
    ds_read_b64_tr_b16 v[46:47], v11 offset:608
    ds_read_b64_tr_b16 v[48:49], v11 offset:4096
    ds_read_b64_tr_b16 v[50:51], v11 offset:4608
    ds_read_b64_tr_b16 v[52:53], v11 offset:4128
    ds_read_b64_tr_b16 v[54:55], v11 offset:4640
    ds_read_b64_tr_b16 v[56:57], v11 offset:4160
    ds_read_b64_tr_b16 v[58:59], v11 offset:4672
    ds_read_b64_tr_b16 v[60:61], v11 offset:4192
    ds_read_b64_tr_b16 v[62:63], v11 offset:4704
    ds_read_b64_tr_b16 v[64:65], v11 offset:8192
    ds_read_b64_tr_b16 v[66:67], v11 offset:8704
    ds_read_b64_tr_b16 v[68:69], v11 offset:8224
    ds_read_b64_tr_b16 v[70:71], v11 offset:8736
    ds_read_b64_tr_b16 v[72:73], v11 offset:8256
    ds_read_b64_tr_b16 v[74:75], v11 offset:8768
    ds_read_b64_tr_b16 v[76:77], v11 offset:8288
    ds_read_b64_tr_b16 v[78:79], v11 offset:8800
    ds_read_b64_tr_b16 v[80:81], v11 offset:12288
    ds_read_b64_tr_b16 v[82:83], v11 offset:12800
    ds_read_b64_tr_b16 v[84:85], v11 offset:12320
    ds_read_b64_tr_b16 v[86:87], v11 offset:12832
    ds_read_b64_tr_b16 v[88:89], v11 offset:12352
    ds_read_b64_tr_b16 v[90:91], v11 offset:12864
    ds_read_b64_tr_b16 v[92:93], v11 offset:12384
    ds_read_b64_tr_b16 v[94:95], v11 offset:12896
    s_waitcnt lgkmcnt(0)
    v_mfma_f32_16x16x32_bf16 v[96:99], v[16:19], v[32:35], 0
    v_mfma_f32_16x16x32_bf16 v[100:103], v[16:19], v[36:39], 0
    v_mfma_f32_16x16x32_bf16 v[104:107], v[16:19], v[40:43], 0
    v_mfma_f32_16x16x32_bf16 v[108:111], v[16:19], v[44:47], 0
    v_mfma_f32_16x16x32_bf16 v[96:99], v[20:23], v[48:51], v[96:99]
    v_mfma_f32_16x16x32_bf16 v[100:103], v[20:23], v[52:55], v[100:103]
    v_mfma_f32_16x16x32_bf16 v[104:107], v[20:23], v[56:59], v[104:107]
    v_mfma_f32_16x16x32_bf16 v[108:111], v[20:23], v[60:63], v[108:111]
    v_mfma_f32_16x16x32_bf16 v[96:99], v[24:27], v[64:67], v[96:99]
    v_mfma_f32_16x16x32_bf16 v[100:103], v[24:27], v[68:71], v[100:103]
    v_mfma_f32_16x16x32_bf16 v[104:107], v[24:27], v[72:75], v[104:107]
    v_mfma_f32_16x16x32_bf16 v[108:111], v[24:27], v[76:79], v[108:111]
    v_mfma_f32_16x16x32_bf16 v[96:99], v[28:31], v[80:83], v[96:99]
    v_mfma_f32_16x16x32_bf16 v[100:103], v[28:31], v[84:87], v[100:103]
    v_mfma_f32_16x16x32_bf16 v[104:107], v[28:31], v[88:91], v[104:107]
    v_mfma_f32_16x16x32_bf16 v[108:111], v[28:31], v[92:95], v[108:111]
    s_nop 4
    v_mov_b32_dpp v12, v96 quad_perm:[0,1,2,3] row_mask:0x1 bank_mask:0xf
    s_nop 1
    v_mov_b32_dpp v12, v100 quad_perm:[0,1,2,3] row_mask:0x2 bank_mask:0xf
    s_nop 1
    v_mov_b32_dpp v12, v104 quad_perm:[0,1,2,3] row_mask:0x4 bank_mask:0xf
    s_nop 1
    v_mov_b32_dpp v12, v108 quad_perm:[0,1,2,3] row_mask:0x8 bank_mask:0xf
    v_mov_b32 v13, v2
    s_mul_i32 s62, s59, 3072
    s_lshl_b32 s63, s60, 6
    s_add_u32 s62, s62, s63
    s_lshl_b32 s62, s62, 3
    s_add_u32 s62, s62, 16384
    v_lshl_add_u32 v14, v0, 3, s62
    buffer_store_dwordx2 v[12:13], v14, s[36:39], 0 offen sc1
    s_branch L_h0_gu
L_h0_nomod:
    s_setprio 1
    s_waitcnt lgkmcnt(0)
    s_barrier
    s_waitcnt lgkmcnt(0)
    s_mul_i32 s6, s6, 0x9E3779B1
    s_add_u32 s6, s6, 0x7F4A7C15
    s_or_b32 s6, s6, 1
    v_mov_b32 v2, s6
    v_mov_b32 v3, 0
L_h0_gu:
    s_and_b32 s58, s88, 1
    s_cmp_eq_u32 s58, 1
    s_cselect_b32 s44, s22, s20
    s_cselect_b32 s45, s23, s21
    s_and_b32 s45, s45, 0xffff
    s_mov_b32 s46, 1409024
    s_mov_b32 s47, 0x20000
    s_mov_b32 s40, s16
    s_and_b32 s41, s17, 0xffff
    s_mov_b32 s42, 4194304
    s_mov_b32 s43, 0x20000
    s_mov_b32 s52, s24
    s_and_b32 s53, s25, 0xffff
    s_mov_b32 s54, 1409024
    s_mov_b32 s55, 0x20000
    s_lshl_b32 s65, s89, 2
    v_mov_b32 v4, 0
    v_mov_b32 v5, 0
    v_mov_b32 v6, 0
    v_mov_b32 v7, 0
    v_mov_b32 v8, 0
    v_mov_b32 v9, 0
    v_mov_b32 v20, 0
    v_mov_b32 v21, 0
    v_mov_b32 v22, 0
    v_mov_b32 v23, 0
    v_mov_b32 v26, 0
    v_mov_b32 v158, 0
    s_mov_b32 s69, 2097152
    s_mov_b64 s[56:57], 0
    s_mov_b64 exec, 0
    s_branch L_gtail
L_gtail_ret:
    s_mov_b64 s[56:57], -1
    s_mov_b64 exec, -1
    s_waitcnt vmcnt(0)
    v_lshrrev_b32 v6, 3, v0
    v_lshlrev_b32 v6, 10, v6
    v_and_b32 v7, 7, v0
    v_lshl_add_u32 v6, v7, 4, v6
    v_lshrrev_b32 v8, 4, v0
    v_and_b32 v7, 15, v0
    v_lshlrev_b32 v10, 10, v8
    v_lshl_add_u32 v10, v7, 4, v10
    v_lshrrev_b32 v8, 5, v0
    v_mul_u32_u24 v9, 2752, v8
    v_and_b32 v7, 31, v0
    v_lshl_add_u32 v9, v7, 4, v9
    s_lshr_b32 s58, s88, 1
    s_mul_i32 s60, s58, 88064
    s_lshl_b32 s63, s90, 6
    s_add_u32 s60, s60, s63
    s_lshl_b32 s63, s89, 2
    s_lshl_b32 s66, 1, s63
    s_sub_u32 s66, s66, 1
    s_mov_b32 s67, s66
    s_lshr_b32 s61, s88, 2
    s_add_u32 s61, s61, s90
    s_lshl_b32 s61, s61, 15
    s_and_b32 s63, s88, 3
    s_lshl_b32 s63, s63, 8
    s_add_u32 s61, s61, s63
    s_lshl_b32 s62, s4, 17
    s_lshl_b32 s63, s5, 7
    s_add_u32 s62, s62, s63
    s_mov_b32 s68, 2097152
L_spin_25:
    ds_read_b64 v[12:13], v3 offset:112
    s_waitcnt lgkmcnt(0)
    v_cmp_ne_u32 vcc, v12, v2
    s_cbranch_vccz L_spinx_26
    s_sleep 2
    s_sub_u32 s68, s68, 1
    s_cbranch_scc0 L_spin_25
L_spinx_26:
    v_readfirstlane_b32 s69, v13
    s_and_b32 s58, s75, 0xe0
    s_lshl_b32 s58, s58, 12
    s_add_u32 s58, s58, 1048576
    s_add_u32 s58, s58, s69
    s_lshr_b32 s63, s88, 2
    s_lshl_b32 s63, s63, 7
    s_add_u32 s58, s58, s63
    v_lshrrev_b32 v20, 3, v0
    v_lshlrev_b32 v20, 12, v20
    v_and_b32 v21, 7, v0
    v_lshl_add_u32 v20, v21, 4, v20
    v_add_u32 v20, s58, v20
    v_lshlrev_b32 v21, 3, v0
    s_mov_b64 exec, s[66:67]
    s_mov_b32 m0, 57344
    s_nop 0
    buffer_load_dwordx4 v9, s[44:47], s60 offen nt lds
    s_add_u32 s60, s60, 5504
    s_mov_b32 m0, 58368
    s_nop 0
    buffer_load_dwordx4 v9, s[44:47], s60 offen nt lds
    s_add_u32 s60, s60, 5504
    s_mov_b32 m0, 59392
    s_nop 0
    buffer_load_dwordx4 v9, s[44:47], s60 offen nt lds
    s_add_u32 s60, s60, 5504
    s_mov_b32 m0, 60416
    s_nop 0
    buffer_load_dwordx4 v9, s[44:47], s60 offen nt lds
    s_add_u32 s60, s60, 5504
    s_mov_b32 m0, 61440
    s_nop 0
    buffer_load_dwordx4 v9, s[44:47], s60 offen nt lds
    s_add_u32 s60, s60, 5504
    s_mov_b32 m0, 62464
    s_nop 0
    buffer_load_dwordx4 v9, s[44:47], s60 offen nt lds
    s_add_u32 s60, s60, 5504
    s_mov_b32 m0, 63488
    s_nop 0
    buffer_load_dwordx4 v9, s[44:47], s60 offen nt lds
    s_add_u32 s60, s60, 5504
    s_mov_b32 m0, 64512
    s_nop 0
    buffer_load_dwordx4 v9, s[44:47], s60 offen nt lds
    s_add_u32 s60, s60, 5504
    s_mov_b32 m0, 65536
    s_nop 0
    buffer_load_dwordx4 v9, s[44:47], s60 offen nt lds
    s_add_u32 s60, s60, 5504
    s_mov_b32 m0, 66560
    s_nop 0
    buffer_load_dwordx4 v9, s[44:47], s60 offen nt lds
    s_add_u32 s60, s60, 5504
    s_mov_b32 m0, 67584
    s_nop 0
    buffer_load_dwordx4 v9, s[44:47], s60 offen nt lds
    s_add_u32 s60, s60, 5504
    s_mov_b32 m0, 68608
    s_nop 0
    buffer_load_dwordx4 v9, s[44:47], s60 offen nt lds
    s_add_u32 s60, s60, 5504
    s_mov_b32 m0, 69632
    s_nop 0
    buffer_load_dwordx4 v9, s[44:47], s60 offen nt lds
    s_add_u32 s60, s60, 5504
    s_mov_b32 m0, 70656
    s_nop 0
    buffer_load_dwordx4 v9, s[44:47], s60 offen nt lds
    s_add_u32 s60, s60, 5504
    s_mov_b32 m0, 71680
    s_nop 0
    buffer_load_dwordx4 v9, s[44:47], s60 offen nt lds
    s_add_u32 s60, s60, 5504
    s_mov_b32 m0, 72704
    s_nop 0
    buffer_load_dwordx4 v9, s[44:47], s60 offen nt lds
    s_mov_b64 exec, -1
    v_lshrrev_b32 v26, 4, v0
    v_and_b32 v24, 7, v0
    v_lshl_add_u32 v28, v24, 2, v26
    v_and_b32 v24, 3, v0
    v_lshl_add_u32 v29, v24, 2, v26
    s_lshr_b32 s63, s88, 1
    s_lshl_b32 s63, s63, 8
    s_add_u32 s63, s63, 24576
    v_lshl_add_u32 v148, v28, 3, s63
    s_and_b32 s63, s88, 3
    s_lshl_b32 s64, s7, 2
    s_add_u32 s63, s63, s64
    s_lshl_b32 s63, s63, 7
    s_add_u32 s63, s63, 24576
    v_lshl_add_u32 v149, v29, 3, s63
    v_add_u32 v31, 10240, v1
    s_mov_b32 s68, 262144
L_poll_27:
    s_mov_b32 s63, 0
    buffer_load_dwordx2 v[48:49], v148, s[36:39], s63 offen sc1
    s_mov_b32 s63, 24576
    buffer_load_dwordx2 v[50:51], v148, s[36:39], s63 offen sc1
    s_mov_b32 s63, 49152
    buffer_load_dwordx2 v[52:53], v148, s[36:39], s63 offen sc1
    s_mov_b32 s63, 73728
    buffer_load_dwordx2 v[54:55], v148, s[36:39], s63 offen sc1
    s_mov_b32 s63, 4096
    buffer_load_dwordx2 v[56:57], v148, s[36:39], s63 offen sc1
    s_mov_b32 s63, 28672
    buffer_load_dwordx2 v[58:59], v148, s[36:39], s63 offen sc1
    s_mov_b32 s63, 53248
    buffer_load_dwordx2 v[60:61], v148, s[36:39], s63 offen sc1
    s_mov_b32 s63, 77824
    buffer_load_dwordx2 v[62:63], v148, s[36:39], s63 offen sc1
    s_mov_b32 s63, 8192
    buffer_load_dwordx2 v[64:65], v148, s[36:39], s63 offen sc1
    s_mov_b32 s63, 32768
    buffer_load_dwordx2 v[66:67], v148, s[36:39], s63 offen sc1
    s_mov_b32 s63, 57344
    buffer_load_dwordx2 v[68:69], v148, s[36:39], s63 offen sc1
    s_mov_b32 s63, 81920
    buffer_load_dwordx2 v[70:71], v148, s[36:39], s63 offen sc1
    s_mov_b32 s63, 0
    buffer_load_dwordx2 v[72:73], v149, s[36:39], s63 offen sc1
    s_mov_b32 s63, 24576
    buffer_load_dwordx2 v[74:75], v149, s[36:39], s63 offen sc1
    s_mov_b32 s63, 49152
    buffer_load_dwordx2 v[76:77], v149, s[36:39], s63 offen sc1
    s_mov_b32 s63, 73728
    buffer_load_dwordx2 v[78:79], v149, s[36:39], s63 offen sc1
    s_mov_b32 s63, 12288
    buffer_load_dwordx2 v[80:81], v149, s[36:39], s63 offen sc1
    s_mov_b32 s63, 36864
    buffer_load_dwordx2 v[82:83], v149, s[36:39], s63 offen sc1
    s_mov_b32 s63, 61440
    buffer_load_dwordx2 v[84:85], v149, s[36:39], s63 offen sc1
    s_mov_b32 s63, 86016
    buffer_load_dwordx2 v[86:87], v149, s[36:39], s63 offen sc1
    buffer_load_dwordx4 v[40:43], v31, s[36:39], 0 offen sc1
    buffer_load_dwordx4 v[44:47], v31, s[36:39], 0 offen offset:1024 sc1
    s_waitcnt vmcnt(0)
    v_xor_b32 v25, v49, v2
    v_bitop3_b32 v25, v25, v51, v2 bitop3:0xf6
    v_bitop3_b32 v25, v25, v53, v2 bitop3:0xf6
    v_bitop3_b32 v25, v25, v55, v2 bitop3:0xf6
    v_bitop3_b32 v25, v25, v57, v2 bitop3:0xf6
    v_bitop3_b32 v25, v25, v59, v2 bitop3:0xf6
    v_bitop3_b32 v25, v25, v61, v2 bitop3:0xf6
    v_bitop3_b32 v25, v25, v63, v2 bitop3:0xf6
    v_bitop3_b32 v25, v25, v65, v2 bitop3:0xf6
    v_bitop3_b32 v25, v25, v67, v2 bitop3:0xf6
    v_bitop3_b32 v25, v25, v69, v2 bitop3:0xf6
    v_bitop3_b32 v25, v25, v71, v2 bitop3:0xf6
    v_bitop3_b32 v25, v25, v73, v2 bitop3:0xf6
    v_bitop3_b32 v25, v25, v75, v2 bitop3:0xf6
    v_bitop3_b32 v25, v25, v77, v2 bitop3:0xf6
    v_bitop3_b32 v25, v25, v79, v2 bitop3:0xf6
    v_bitop3_b32 v25, v25, v81, v2 bitop3:0xf6
    v_bitop3_b32 v25, v25, v83, v2 bitop3:0xf6
    v_bitop3_b32 v25, v25, v85, v2 bitop3:0xf6
    v_bitop3_b32 v25, v25, v87, v2 bitop3:0xf6
    v_bitop3_b32 v25, v25, v41, v2 bitop3:0xf6
    v_bitop3_b32 v25, v25, v43, v2 bitop3:0xf6
    v_bitop3_b32 v25, v25, v45, v2 bitop3:0xf6
    v_bitop3_b32 v25, v25, v47, v2 bitop3:0xf6
    v_cmp_ne_u32 vcc, 0, v25
    s_cbranch_vccz L_pollx_28
    s_mov_b64 exec, vcc
    s_sleep 2
    s_sub_u32 s68, s68, 1
    s_cbranch_scc0 L_poll_27
L_pollx_28:
    s_mov_b64 exec, s[56:57]
    v_add_f32 v48, v48, v50
    v_add_f32 v56, v56, v58
    v_add_f32 v64, v64, v66
    v_add_f32 v72, v72, v74
    v_add_f32 v80, v80, v82
    v_add_f32 v52, v52, v54
    v_add_f32 v60, v60, v62
    v_add_f32 v68, v68, v70
    v_add_f32 v76, v76, v78
    v_add_f32 v84, v84, v86
    v_add_f32 v48, v48, v52
    v_add_f32 v56, v56, v60
    v_add_f32 v64, v64, v68
    v_add_f32 v72, v72, v76
    v_add_f32 v80, v80, v84
    v_cvt_pk_bf16_f32 v48, v48, v48
    v_cvt_pk_bf16_f32 v56, v56, v56
    v_cvt_pk_bf16_f32 v64, v64, v64
    v_cvt_pk_bf16_f32 v72, v72, v72
    v_cvt_pk_bf16_f32 v80, v80, v80
    v_and_b32 v48, 0xffff0000, v48
    v_and_b32 v56, 0xffff0000, v56
    v_and_b32 v64, 0xffff0000, v64
    v_and_b32 v72, 0xffff0000, v72
    v_and_b32 v80, 0xffff0000, v80
    v_add_f32 v64, 1.0, v64
    v_cvt_pk_bf16_f32 v64, v64, v64
    v_and_b32 v64, 0xffff0000, v64
    v_mov_b32 v32, v48
    v_mov_b32 v33, v64
    v_mov_b32 v34, v72
    v_mov_b32 v35, v80
    ds_write_b128 v1, v[32:35] offset:6912
    v_and_b32 v25, 8, v0
    v_cmp_eq_u32 vcc, 0, v25
    v_lshlrev_b32 v24, 1, v28
    v_lshl_add_u32 v24, v25, 3, v24
    v_cndmask_b32 v25, v56, v64, vcc
    v_cvt_pk_bf16_f32 v25, v25, v25
    ds_write_b16 v24, v25 offset:1728
    ds_write_b32 v3, v2 offset:76
    ds_write_b32 v3, v2 offset:68
    s_mov_b32 s68, 2097152
L_spin_29:
    ds_read_b128 v[12:15], v3 offset:48
    s_waitcnt lgkmcnt(0)
    v_xor_b32 v16, v12, v2
    v_bitop3_b32 v16, v16, v13, v2 bitop3:0xf6
    v_bitop3_b32 v16, v16, v14, v2 bitop3:0xf6
    v_bitop3_b32 v16, v16, v15, v2 bitop3:0xf6
    v_cmp_ne_u32 vcc, 0, v16
    s_cbranch_vccz L_spinx_30
    s_sleep 2
    s_sub_u32 s68, s68, 1
    s_cbranch_scc0 L_spin_29
L_spinx_30:
    s_mov_b32 m0, 40960
    s_nop 0
    buffer_load_dwordx4 v6, s[40:43], s62 offen nt lds
    s_add_u32 s62, s62, 8192
    s_mov_b32 m0, 41984
    s_nop 0
    buffer_load_dwordx4 v6, s[40:43], s62 offen nt lds
    s_add_u32 s62, s62, 8192
    s_mov_b32 m0, 43008
    s_nop 0
    buffer_load_dwordx4 v6, s[40:43], s62 offen nt lds
    s_add_u32 s62, s62, 8192
    s_mov_b32 m0, 44032
    s_nop 0
    buffer_load_dwordx4 v6, s[40:43], s62 offen nt lds
    s_add_u32 s62, s62, 8192
    s_mov_b32 m0, 45056
    s_nop 0
    buffer_load_dwordx4 v6, s[40:43], s62 offen nt lds
    s_add_u32 s62, s62, 8192
    s_mov_b32 m0, 46080
    s_nop 0
    buffer_load_dwordx4 v6, s[40:43], s62 offen nt lds
    s_add_u32 s62, s62, 8192
    s_mov_b32 m0, 47104
    s_nop 0
    buffer_load_dwordx4 v6, s[40:43], s62 offen nt lds
    s_add_u32 s62, s62, 8192
    s_mov_b32 m0, 48128
    s_nop 0
    buffer_load_dwordx4 v6, s[40:43], s62 offen nt lds
    s_add_u32 s62, s62, 8192
    s_mov_b32 m0, 49152
    s_nop 0
    buffer_load_dwordx4 v6, s[40:43], s62 offen nt lds
    s_add_u32 s62, s62, 8192
    s_mov_b32 m0, 50176
    s_nop 0
    buffer_load_dwordx4 v6, s[40:43], s62 offen nt lds
    s_add_u32 s62, s62, 8192
    s_mov_b32 m0, 51200
    s_nop 0
    buffer_load_dwordx4 v6, s[40:43], s62 offen nt lds
    s_add_u32 s62, s62, 8192
    s_mov_b32 m0, 52224
    s_nop 0
    buffer_load_dwordx4 v6, s[40:43], s62 offen nt lds
    s_add_u32 s62, s62, 8192
    s_mov_b32 m0, 53248
    s_nop 0
    buffer_load_dwordx4 v6, s[40:43], s62 offen nt lds
    s_add_u32 s62, s62, 8192
    s_mov_b32 m0, 54272
    s_nop 0
    buffer_load_dwordx4 v6, s[40:43], s62 offen nt lds
    s_add_u32 s62, s62, 8192
    s_mov_b32 m0, 55296
    s_nop 0
    buffer_load_dwordx4 v6, s[40:43], s62 offen nt lds
    s_add_u32 s62, s62, 8192
    s_mov_b32 m0, 56320
    s_nop 0
    buffer_load_dwordx4 v6, s[40:43], s62 offen nt lds
    s_cmp_ge_u32 s88, s65
    s_cbranch_scc1 L_h0_nodn
    s_waitcnt vmcnt(0)
    ds_write_b32 v3, v2 offset:64
    s_mov_b32 s68, 2097152
L_spin_31:
    ds_read_b32 v12, v3 offset:80
    s_waitcnt lgkmcnt(0)
    v_cmp_ne_u32 vcc, v12, v2
    s_cbranch_vccz L_spinx_32
    s_sub_u32 s68, s68, 1
    s_cbranch_scc0 L_spin_31
L_spinx_32:
    s_mov_b32 m0, 73728
    s_nop 0
    buffer_load_dwordx4 v10, s[52:55], s61 offen nt lds
    s_add_u32 s61, s61, 4096
    s_mov_b32 m0, 74752
    s_nop 0
    buffer_load_dwordx4 v10, s[52:55], s61 offen nt lds
    s_add_u32 s61, s61, 4096
    s_mov_b32 m0, 75776
    s_nop 0
    buffer_load_dwordx4 v10, s[52:55], s61 offen nt lds
    s_add_u32 s61, s61, 4096
    s_mov_b32 m0, 76800
    s_nop 0
    buffer_load_dwordx4 v10, s[52:55], s61 offen nt lds
    s_add_u32 s61, s61, 4096
    s_mov_b32 m0, 77824
    s_nop 0
    buffer_load_dwordx4 v10, s[52:55], s61 offen nt lds
    s_add_u32 s61, s61, 4096
    s_mov_b32 m0, 78848
    s_nop 0
    buffer_load_dwordx4 v10, s[52:55], s61 offen nt lds
    s_add_u32 s61, s61, 4096
    s_mov_b32 m0, 79872
    s_nop 0
    buffer_load_dwordx4 v10, s[52:55], s61 offen nt lds
    s_add_u32 s61, s61, 4096
    s_mov_b32 m0, 80896
    s_nop 0
    buffer_load_dwordx4 v10, s[52:55], s61 offen nt lds
    s_waitcnt vmcnt(0)
    ds_write_b32 v3, v2 offset:72
    s_mov_b32 s68, 262144
L_poll_33:
    s_mov_b32 s62, 0
    buffer_load_dwordx4 v[32:35], v20, s[36:39], s62 offen offset:2048 sc1
    s_mov_b32 s62, 32768
    buffer_load_dwordx4 v[36:39], v20, s[36:39], s62 offen offset:2048 sc1
    s_mov_b32 s62, 65536
    buffer_load_dwordx4 v[40:43], v20, s[36:39], s62 offen offset:2048 sc1
    s_mov_b32 s62, 98304
    buffer_load_dwordx4 v[44:47], v20, s[36:39], s62 offen offset:2048 sc1
    s_mov_b32 s62, 0
    buffer_load_dwordx4 v[48:51], v20, s[36:39], s62 offen offset:2816 sc1
    s_mov_b32 s62, 32768
    buffer_load_dwordx4 v[52:55], v20, s[36:39], s62 offen offset:2816 sc1
    s_mov_b32 s62, 65536
    buffer_load_dwordx4 v[56:59], v20, s[36:39], s62 offen offset:2816 sc1
    s_mov_b32 s62, 98304
    buffer_load_dwordx4 v[60:63], v20, s[36:39], s62 offen offset:2816 sc1
    s_waitcnt vmcnt(0)
    v_max3_u32 v25, v32, v33, v34
    v_max3_u32 v27, v48, v49, v50
    v_max3_u32 v25, v25, v35, v36
    v_max3_u32 v27, v27, v51, v52
    v_max3_u32 v25, v25, v37, v38
    v_max3_u32 v27, v27, v53, v54
    v_max3_u32 v25, v25, v39, v40
    v_max3_u32 v27, v27, v55, v56
    v_max3_u32 v25, v25, v41, v42
    v_max3_u32 v27, v27, v57, v58
    v_max3_u32 v25, v25, v43, v44
    v_max3_u32 v27, v27, v59, v60
    v_max3_u32 v25, v25, v45, v46
    v_max3_u32 v27, v27, v61, v62
    v_max_u32 v25, v25, v47
    v_max_u32 v27, v27, v63
    v_max_u32 v25, v25, v27
    v_cmp_eq_u32 vcc, -1, v25
    s_cbranch_vccz L_pollx_34
    s_mov_b64 exec, vcc
    s_sub_u32 s68, s68, 1
    s_cbranch_scc0 L_poll_33
L_pollx_34:
    s_mov_b64 exec, s[56:57]
    v_add_f32 v32, v32, v36
    v_add_f32 v33, v33, v37
    v_add_f32 v34, v34, v38
    v_add_f32 v35, v35, v39
    v_add_f32 v40, v40, v44
    v_add_f32 v41, v41, v45
    v_add_f32 v42, v42, v46
    v_add_f32 v43, v43, v47
    v_add_f32 v32, v32, v40
    v_add_f32 v33, v33, v41
    v_add_f32 v34, v34, v42
    v_add_f32 v35, v35, v43
    v_add_f32 v48, v48, v52
    v_add_f32 v49, v49, v53
    v_add_f32 v50, v50, v54
    v_add_f32 v51, v51, v55
    v_add_f32 v56, v56, v60
    v_add_f32 v57, v57, v61
    v_add_f32 v58, v58, v62
    v_add_f32 v59, v59, v63
    v_add_f32 v48, v48, v56
    v_add_f32 v49, v49, v57
    v_add_f32 v50, v50, v58
    v_add_f32 v51, v51, v59
    v_permlane32_swap_b32 v32, v34
    v_permlane32_swap_b32 v33, v35
    v_add_f32 v32, v32, v34
    v_add_f32 v33, v33, v35
    s_nop 1
    v_permlane16_swap_b32 v32, v33
    v_add_f32 v32, v32, v33
    v_permlane32_swap_b32 v48, v50
    v_permlane32_swap_b32 v49, v51
    v_add_f32 v48, v48, v50
    v_add_f32 v49, v49, v51
    s_nop 1
    v_permlane16_swap_b32 v48, v49
    v_add_f32 v48, v48, v49
    v_mov_b32 v33, v48
    ds_write_b64 v21, v[32:33] offset:6144
    ds_write_b32 v3, v2 offset:120
    s_endpgm
L_h0_nodn:
    s_waitcnt vmcnt(0)
    ds_write_b32 v3, v2 offset:64
    s_endpgm
L_gwave:
    s_setprio 2
    s_mov_b32 s40, s8
    s_and_b32 s41, s9, 0xffff
    s_mov_b32 s42, 1024
    s_mov_b32 s43, 0x20000
    s_mov_b32 s44, s14
    s_and_b32 s45, s15, 0xffff
    s_mov_b32 s46, 4194304
    s_mov_b32 s47, 0x20000
    buffer_load_dwordx4 v[4:7], v1, s[40:43], 0 offen
    s_lshl_b32 s58, s5, 7
    v_lshl_add_u32 v8, v0, 1, s58
    buffer_load_ushort v9, v8, s[40:43], 0 offen
    v_lshrrev_b32 v26, 4, v0
    v_and_b32 v24, 7, v0
    v_lshl_add_u32 v28, v24, 2, v26
    v_and_b32 v24, 3, v0
    v_lshl_add_u32 v29, v24, 2, v26
    s_lshr_b32 s58, s88, 1
    s_lshl_b32 s59, s58, 6
    v_lshl_add_u32 v8, v28, 1, s59
    buffer_load_ushort v14, v8, s[40:43], 0 offen
    s_and_b32 s60, s88, 3
    s_lshl_b32 s61, s7, 2
    s_add_u32 s60, s60, s61
    s_lshl_b32 s59, s60, 5
    v_lshl_add_u32 v23, v29, 1, s59
    buffer_load_ushort v15, v23, s[40:43], 0 offen
    v_lshrrev_b32 v10, 4, v0
    v_lshlrev_b32 v10, 13, v10
    v_and_b32 v11, 15, v0
    v_lshl_add_u32 v10, v11, 4, v10
    s_lshl_b32 s62, s5, 19
    s_lshl_b32 s63, s4, 8
    s_add_u32 s62, s62, s63
    s_barrier
    s_waitcnt lgkmcnt(0)
    s_mul_i32 s6, s6, 0x9E3779B1
    s_add_u32 s6, s6, 0x7F4A7C15
    s_or_b32 s6, s6, 1
    v_mov_b32 v2, s6
    v_mov_b32 v3, 0
    s_getreg_b32 s91, hwreg(HW_REG_XCC_ID)
    s_lshl_b32 s59, s5, 9
    s_add_u32 s59, s59, 16384
    v_lshl_add_u32 v24, v0, 3, s59
    s_lshl_b32 s59, s58, 8
    s_add_u32 s59, s59, 24576
    v_lshl_add_u32 v148, v28, 3, s59
    s_lshl_b32 s59, s60, 7
    s_add_u32 s59, s59, 24576
    v_lshl_add_u32 v149, v29, 3, s59
    s_lshl_b32 s59, s7, 8
    s_add_u32 s59, s59, 8192
    v_and_b32 v25, 31, v0
    v_lshl_add_u32 v22, v25, 3, s59
    s_waitcnt vmcnt(0)
    s_mov_b32 m0, 24576
    s_nop 0
    buffer_load_dwordx4 v10, s[44:47], s62 offen nt lds
    s_add_u32 s62, s62, 32768
    s_mov_b32 m0, 25600
    s_nop 0
    buffer_load_dwordx4 v10, s[44:47], s62 offen nt lds
    s_add_u32 s62, s62, 32768
    s_mov_b32 m0, 26624
    s_nop 0
    buffer_load_dwordx4 v10, s[44:47], s62 offen nt lds
    s_add_u32 s62, s62, 32768
    s_mov_b32 m0, 27648
    s_nop 0
    buffer_load_dwordx4 v10, s[44:47], s62 offen nt lds
    s_add_u32 s62, s62, 32768
    s_mov_b32 m0, 28672
    s_nop 0
    buffer_load_dwordx4 v10, s[44:47], s62 offen nt lds
    s_add_u32 s62, s62, 32768
    s_mov_b32 m0, 29696
    s_nop 0
    buffer_load_dwordx4 v10, s[44:47], s62 offen nt lds
    s_add_u32 s62, s62, 32768
    s_mov_b32 m0, 30720
    s_nop 0
    buffer_load_dwordx4 v10, s[44:47], s62 offen nt lds
    s_add_u32 s62, s62, 32768
    s_mov_b32 m0, 31744
    s_nop 0
    buffer_load_dwordx4 v10, s[44:47], s62 offen nt lds
    s_add_u32 s62, s62, 32768
    s_mov_b32 m0, 32768
    s_nop 0
    buffer_load_dwordx4 v10, s[44:47], s62 offen nt lds
    s_add_u32 s62, s62, 32768
    s_mov_b32 m0, 33792
    s_nop 0
    buffer_load_dwordx4 v10, s[44:47], s62 offen nt lds
    s_add_u32 s62, s62, 32768
    s_mov_b32 m0, 34816
    s_nop 0
    buffer_load_dwordx4 v10, s[44:47], s62 offen nt lds
    s_add_u32 s62, s62, 32768
    s_mov_b32 m0, 35840
    s_nop 0
    buffer_load_dwordx4 v10, s[44:47], s62 offen nt lds
    s_add_u32 s62, s62, 32768
    s_mov_b32 m0, 36864
    s_nop 0
    buffer_load_dwordx4 v10, s[44:47], s62 offen nt lds
    s_add_u32 s62, s62, 32768
    s_mov_b32 m0, 37888
    s_nop 0
    buffer_load_dwordx4 v10, s[44:47], s62 offen nt lds
    s_add_u32 s62, s62, 32768
    s_mov_b32 m0, 38912
    s_nop 0
    buffer_load_dwordx4 v10, s[44:47], s62 offen nt lds
    s_add_u32 s62, s62, 32768
    s_mov_b32 m0, 39936
    s_nop 0
    buffer_load_dwordx4 v10, s[44:47], s62 offen nt lds
    s_mov_b32 s44, s30
    s_and_b32 s45, s31, 0xffff
    s_mov_b32 s46, 1024
    s_mov_b32 s47, 0x20000
    v_lshlrev_b32 v32, 16, v4
    v_and_b32 v33, 0xffff0000, v4
    v_lshlrev_b32 v34, 16, v5
    v_and_b32 v35, 0xffff0000, v5
    v_lshlrev_b32 v36, 16, v6
    v_and_b32 v37, 0xffff0000, v6
    v_lshlrev_b32 v38, 16, v7
    v_and_b32 v39, 0xffff0000, v7
    v_add_f32 v40, v32, v33
    v_add_f32 v40, v40, v34
    v_add_f32 v40, v40, v35
    v_add_f32 v40, v40, v36
    v_add_f32 v40, v40, v37
    v_add_f32 v40, v40, v38
    v_add_f32 v40, v40, v39
    s_nop 1
    v_add_f32_dpp v40, v40, v40 quad_perm:[1,0,3,2] row_mask:0xf bank_mask:0xf
    s_nop 1
    v_add_f32_dpp v40, v40, v40 quad_perm:[2,3,0,1] row_mask:0xf bank_mask:0xf
    s_nop 1
    v_add_f32_dpp v40, v40, v40 row_half_mirror row_mask:0xf bank_mask:0xf
    s_nop 1
    v_add_f32_dpp v40, v40, v40 row_mirror row_mask:0xf bank_mask:0xf
    v_mov_b32 v41, v40
    s_nop 1
    v_permlane16_swap_b32 v40, v41
    v_add_f32 v40, v40, v41
    v_mov_b32 v41, v40
    s_nop 1
    v_permlane32_swap_b32 v40, v41
    v_add_f32 v40, v40, v41
    v_mul_f32 v20, 0x3b000000, v40
    v_sub_f32 v41, v32, v20
    v_mul_f32 v40, v41, v41
    v_sub_f32 v41, v33, v20
    v_fmac_f32 v40, v41, v41
    v_sub_f32 v41, v34, v20
    v_fmac_f32 v40, v41, v41
    v_sub_f32 v41, v35, v20
    v_fmac_f32 v40, v41, v41
    v_sub_f32 v41, v36, v20
    v_fmac_f32 v40, v41, v41
    v_sub_f32 v41, v37, v20
    v_fmac_f32 v40, v41, v41
    v_sub_f32 v41, v38, v20
    v_fmac_f32 v40, v41, v41
    v_sub_f32 v41, v39, v20
    v_fmac_f32 v40, v41, v41
    s_nop 1
    v_add_f32_dpp v40, v40, v40 quad_perm:[1,0,3,2] row_mask:0xf bank_mask:0xf
    s_nop 1
    v_add_f32_dpp v40, v40, v40 quad_perm:[2,3,0,1] row_mask:0xf bank_mask:0xf
    s_nop 1
    v_add_f32_dpp v40, v40, v40 row_half_mirror row_mask:0xf bank_mask:0xf
    s_nop 1
    v_add_f32_dpp v40, v40, v40 row_mirror row_mask:0xf bank_mask:0xf
    v_mov_b32 v41, v40
    s_nop 1
    v_permlane16_swap_b32 v40, v41
    v_add_f32 v40, v40, v41
    v_mov_b32 v41, v40
    s_nop 1
    v_permlane32_swap_b32 v40, v41
    v_add_f32 v40, v40, v41
    v_mul_f32 v21, 0x3b000000, v40
    v_cvt_pk_bf16_f32 v21, v21, v21
    v_and_b32 v21, 0xffff0000, v21
    v_add_f32 v21, 0x3727c5ac, v21
    v_cvt_pk_bf16_f32 v21, v21, v21
    v_and_b32 v21, 0xffff0000, v21
    v_sqrt_f32 v21, v21
    s_nop 0
    v_cvt_pk_bf16_f32 v21, v21, v21
    v_and_b32 v21, 0xffff0000, v21
    v_cvt_pk_bf16_f32 v20, v20, v20
    v_and_b32 v20, 0xffff0000, v20
    v_rcp_f32 v40, v21
    v_lshlrev_b32 v9, 16, v9
    v_sub_f32 v9, v9, v20
    v_cvt_pk_bf16_f32 v9, v9, v9
    v_and_b32 v9, 0xffff0000, v9
    v_mul_f32 v41, v9, v40
    v_fma_f32 v9, -v41, v21, v9
    v_fma_f32 v9, v9, v40, v41
    v_cvt_pk_bf16_f32 v9, v9, v9
    v_and_b32 v9, 0xffff0000, v9
    v_lshlrev_b32 v14, 16, v14
    v_lshlrev_b32 v15, 16, v15
    v_lshrrev_b32 v27, 4, v0
    v_bfe_u32 v25, v0, 2, 2
    v_lshl_add_u32 v27, v27, 3, v25
    v_lshlrev_b32 v27, 8, v27
    v_and_b32 v25, 3, v0
    v_lshl_add_u32 v27, v25, 3, v27
    v_add_u32 v27, 24576, v27
    v_mov_b32 v21, v27
    v_lshlrev_b32 v26, 4, v26
    s_waitcnt vmcnt(0)
    s_mov_b32 s62, 0
    buffer_load_dwordx2 v[100:101], v24, s[36:39], s62 offen sc1
    s_mov_b32 s62, 4096
    buffer_load_dwordx2 v[108:109], v24, s[36:39], s62 offen sc1
    s_mov_b32 s62, 24576
    buffer_load_dwordx2 v[102:103], v24, s[36:39], s62 offen sc1
    s_mov_b32 s62, 28672
    buffer_load_dwordx2 v[110:111], v24, s[36:39], s62 offen sc1
    s_mov_b32 s62, 49152
    buffer_load_dwordx2 v[104:105], v24, s[36:39], s62 offen sc1
    s_mov_b32 s62, 53248
    buffer_load_dwordx2 v[112:113], v24, s[36:39], s62 offen sc1
    s_mov_b32 s62, 73728
    buffer_load_dwordx2 v[106:107], v24, s[36:39], s62 offen sc1
    s_mov_b32 s62, 77824
    buffer_load_dwordx2 v[114:115], v24, s[36:39], s62 offen sc1
    buffer_load_dwordx2 v[156:157], v22, s[36:39], 0 offen sc1
    s_mov_b32 s68, 262144
L_p1_35:
    s_waitcnt vmcnt(0)
    v_xor_b32 v25, v101, v2
    v_bitop3_b32 v25, v25, v103, v2 bitop3:0xf6
    v_bitop3_b32 v25, v25, v105, v2 bitop3:0xf6
    v_bitop3_b32 v25, v25, v107, v2 bitop3:0xf6
    v_bitop3_b32 v25, v25, v109, v2 bitop3:0xf6
    v_bitop3_b32 v25, v25, v111, v2 bitop3:0xf6
    v_bitop3_b32 v25, v25, v113, v2 bitop3:0xf6
    v_bitop3_b32 v25, v25, v115, v2 bitop3:0xf6
    v_bitop3_b32 v25, v25, v157, v2 bitop3:0xf6
    v_cmp_ne_u32 vcc, 0, v25
    s_cbranch_vccz L_p1x_36
    s_sleep 2
    s_mov_b32 s62, 0
    buffer_load_dwordx2 v[100:101], v24, s[36:39], s62 offen sc1
    s_mov_b32 s62, 4096
    buffer_load_dwordx2 v[108:109], v24, s[36:39], s62 offen sc1
    s_mov_b32 s62, 24576
    buffer_load_dwordx2 v[102:103], v24, s[36:39], s62 offen sc1
    s_mov_b32 s62, 28672
    buffer_load_dwordx2 v[110:111], v24, s[36:39], s62 offen sc1
    s_mov_b32 s62, 49152
    buffer_load_dwordx2 v[104:105], v24, s[36:39], s62 offen sc1
    s_mov_b32 s62, 53248
    buffer_load_dwordx2 v[112:113], v24, s[36:39], s62 offen sc1
    s_mov_b32 s62, 73728
    buffer_load_dwordx2 v[106:107], v24, s[36:39], s62 offen sc1
    s_mov_b32 s62, 77824
    buffer_load_dwordx2 v[114:115], v24, s[36:39], s62 offen sc1
    buffer_load_dwordx2 v[156:157], v22, s[36:39], 0 offen sc1
    s_sub_u32 s68, s68, 1
    s_cbranch_scc0 L_p1_35
    s_waitcnt vmcnt(0)
L_p1x_36:
    ds_write_b32 v3, v2 offset:124
    ds_read_b64_tr_b16 v[36:37], v21 offset:0
    ds_read_b64_tr_b16 v[38:39], v21 offset:1024
    ds_read_b64_tr_b16 v[40:41], v21 offset:32
    ds_read_b64_tr_b16 v[42:43], v21 offset:1056
    ds_read_b64_tr_b16 v[44:45], v21 offset:64
    ds_read_b64_tr_b16 v[46:47], v21 offset:1088
    ds_read_b64_tr_b16 v[48:49], v21 offset:96
    ds_read_b64_tr_b16 v[50:51], v21 offset:1120
    ds_read_b64_tr_b16 v[52:53], v21 offset:128
    ds_read_b64_tr_b16 v[54:55], v21 offset:1152
    ds_read_b64_tr_b16 v[56:57], v21 offset:160
    ds_read_b64_tr_b16 v[58:59], v21 offset:1184
    ds_read_b64_tr_b16 v[60:61], v21 offset:192
    ds_read_b64_tr_b16 v[62:63], v21 offset:1216
    ds_read_b64_tr_b16 v[64:65], v21 offset:224
    ds_read_b64_tr_b16 v[66:67], v21 offset:1248
    ds_read_b64_tr_b16 v[68:69], v21 offset:8192
    ds_read_b64_tr_b16 v[70:71], v21 offset:9216
    ds_read_b64_tr_b16 v[72:73], v21 offset:8224
    ds_read_b64_tr_b16 v[74:75], v21 offset:9248
    ds_read_b64_tr_b16 v[76:77], v21 offset:8256
    ds_read_b64_tr_b16 v[78:79], v21 offset:9280
    ds_read_b64_tr_b16 v[80:81], v21 offset:8288
    ds_read_b64_tr_b16 v[82:83], v21 offset:9312
    ds_read_b64_tr_b16 v[84:85], v21 offset:8320
    ds_read_b64_tr_b16 v[86:87], v21 offset:9344
    ds_read_b64_tr_b16 v[88:89], v21 offset:8352
    ds_read_b64_tr_b16 v[90:91], v21 offset:9376
    ds_read_b64_tr_b16 v[92:93], v21 offset:8384
    ds_read_b64_tr_b16 v[94:95], v21 offset:9408
    ds_read_b64_tr_b16 v[96:97], v21 offset:8416
    ds_read_b64_tr_b16 v[98:99], v21 offset:9440
    v_cmp_ne_u32 vcc, s91, v156
    s_cmp_eq_u64 vcc, 0
    s_cselect_b32 s69, 2097152, 0
    s_cmp_lg_u32 s69, 0
    s_cbranch_scc1 L_g_islocal
    v_mov_b32 v4, -1
    v_mov_b32 v5, -1
    v_mov_b32 v6, -1
    v_mov_b32 v7, -1
    v_add_u32 v13, s74, v1
    buffer_store_dwordx4 v[4:7], v13, s[36:39], 0 offen offset:0 sc1
    buffer_store_dwordx4 v[4:7], v13, s[36:39], 0 offen offset:1024 sc1
    buffer_store_dwordx4 v[4:7], v13, s[36:39], 0 offen offset:2048 sc1
    buffer_store_dwordx4 v[4:7], v13, s[36:39], 0 offen offset:3072 sc1
    s_lshl_b32 s59, s75, 3
    s_add_u32 s59, s59, 12288
    v_mov_b32 v13, s59
    v_mov_b32 v158, 0
    v_mov_b32 v159, v2
    s_waitcnt vmcnt(0)
    s_mov_b64 exec, 1
    buffer_store_dwordx2 v[158:159], v13, s[36:39], 0 offen sc1
    s_mov_b64 exec, -1
    s_lshl_b32 s59, s7, 8
    s_add_u32 s59, s59, 12288
    v_and_b32 v13, 31, v0
    v_lshl_add_u32 v13, v13, 3, s59
    s_mov_b32 s68, 262144
L_poll_37:
    buffer_load_dwordx2 v[158:159], v13, s[36:39], 0 offen sc1
    s_waitcnt vmcnt(0)
    v_xor_b32 v25, v159, v2
    v_cmp_ne_u32 vcc, 0, v25
    s_cbranch_vccz L_pollx_38
    s_mov_b64 exec, vcc
    s_sleep 2
    s_sub_u32 s68, s68, 1
    s_cbranch_scc0 L_poll_37
L_pollx_38:
    s_mov_b64 exec, s[56:57]
L_g_islocal:
    v_add_f32 v100, v100, v102
    v_add_f32 v108, v108, v110
    v_add_f32 v104, v104, v106
    v_add_f32 v112, v112, v114
    v_add_f32 v100, v100, v104
    v_add_f32 v108, v108, v112
    v_cvt_pk_bf16_f32 v100, v100, v100
    v_cvt_pk_bf16_f32 v108, v108, v108
    v_and_b32 v100, 0xffff0000, v100
    v_and_b32 v108, 0xffff0000, v108
    v_add_f32 v108, 1.0, v108
    v_cvt_pk_bf16_f32 v108, v108, v108
    v_and_b32 v108, 0xffff0000, v108
    v_mul_f32 v9, v9, v108
    v_cvt_pk_bf16_f32 v9, v9, v9
    v_and_b32 v9, 0xffff0000, v9
    v_add_f32 v9, v9, v100
    v_cvt_pk_bf16_f32 v9, v9, v9
    v_lshlrev_b32 v25, 1, v0
    ds_write_b16 v25, v9 offset:1024
    ds_read_b128 v[28:31], v26 offset:1024
    ds_read_b128 v[32:35], v26 offset:1088
    v_mov_b32 v24, v2
    v_mov_b32 v25, s69
    ds_write_b64 v3, v[24:25] offset:112
    s_waitcnt lgkmcnt(0)
    v_mfma_f32_16x16x32_bf16 v[100:103], v[28:31], v[36:39], 0
    v_mfma_f32_16x16x32_bf16 v[104:107], v[28:31], v[40:43], 0
    v_mfma_f32_16x16x32_bf16 v[108:111], v[28:31], v[44:47], 0
    v_mfma_f32_16x16x32_bf16 v[112:115], v[28:31], v[48:51], 0
    v_mfma_f32_16x16x32_bf16 v[116:119], v[28:31], v[52:55], 0
    v_mfma_f32_16x16x32_bf16 v[120:123], v[28:31], v[56:59], 0
    v_mfma_f32_16x16x32_bf16 v[124:127], v[28:31], v[60:63], 0
    v_mfma_f32_16x16x32_bf16 v[128:131], v[28:31], v[64:67], 0
    v_mfma_f32_16x16x32_bf16 v[100:103], v[32:35], v[68:71], v[100:103]
    v_mfma_f32_16x16x32_bf16 v[104:107], v[32:35], v[72:75], v[104:107]
    v_mfma_f32_16x16x32_bf16 v[108:111], v[32:35], v[76:79], v[108:111]
    v_mfma_f32_16x16x32_bf16 v[112:115], v[32:35], v[80:83], v[112:115]
    v_mfma_f32_16x16x32_bf16 v[116:119], v[32:35], v[84:87], v[116:119]
    v_mfma_f32_16x16x32_bf16 v[120:123], v[32:35], v[88:91], v[120:123]
    v_mfma_f32_16x16x32_bf16 v[124:127], v[32:35], v[92:95], v[124:127]
    v_mfma_f32_16x16x32_bf16 v[128:131], v[32:35], v[96:99], v[128:131]
    s_nop 0
    v_mov_b32_dpp v132, v100 quad_perm:[0,1,2,3] row_mask:0x1 bank_mask:0xf
    s_nop 1
    v_mov_b32_dpp v132, v104 quad_perm:[0,1,2,3] row_mask:0x2 bank_mask:0xf
    s_nop 1
    v_mov_b32_dpp v132, v108 quad_perm:[0,1,2,3] row_mask:0x4 bank_mask:0xf
    s_nop 1
    v_mov_b32_dpp v132, v112 quad_perm:[0,1,2,3] row_mask:0x8 bank_mask:0xf
    v_mov_b32_dpp v133, v116 quad_perm:[0,1,2,3] row_mask:0x1 bank_mask:0xf
    s_nop 1
    v_mov_b32_dpp v133, v120 quad_perm:[0,1,2,3] row_mask:0x2 bank_mask:0xf
    s_nop 1
    v_mov_b32_dpp v133, v124 quad_perm:[0,1,2,3] row_mask:0x4 bank_mask:0xf
    s_nop 1
    v_mov_b32_dpp v133, v128 quad_perm:[0,1,2,3] row_mask:0x8 bank_mask:0xf
    s_add_u32 s59, s74, 0
    v_lshl_add_u32 v25, v0, 2, s59
    s_cmp_lg_u32 s69, 0
    s_cbranch_scc0 L_pg_39
    buffer_store_dword v132, v25, s[36:39], s96 offen
L_pd_40:
    s_cmp_lg_u32 s69, 0
    s_cbranch_scc0 L_pg_41
    buffer_store_dword v133, v25, s[36:39], s96 offen offset:256
L_pd_42:
    s_and_b32 s58, s75, 0xf8
    s_lshl_b32 s58, s58, 12
    s_add_u32 s58, s58, 1048576
    s_add_u32 s58, s58, s69
    v_lshrrev_b32 v24, 5, v0
    v_lshlrev_b32 v6, 12, v24
    v_and_b32 v25, 31, v0
    v_lshl_add_u32 v6, v25, 4, v6
    v_add_u32 v6, s58, v6
    v_lshlrev_b32 v7, 3, v25
    v_lshl_add_u32 v7, v24, 2, v7
    s_mov_b32 s68, 262144
L_poll_43:
    s_mov_b32 s62, 0
    buffer_load_dwordx4 v[32:35], v6, s[36:39], s62 offen offset:0 sc1
    s_mov_b32 s62, 8192
    buffer_load_dwordx4 v[36:39], v6, s[36:39], s62 offen offset:0 sc1
    s_mov_b32 s62, 16384
    buffer_load_dwordx4 v[40:43], v6, s[36:39], s62 offen offset:0 sc1
    s_mov_b32 s62, 24576
    buffer_load_dwordx4 v[44:47], v6, s[36:39], s62 offen offset:0 sc1
    s_waitcnt vmcnt(0)
    v_max3_u32 v25, v32, v33, v34
    v_max3_u32 v27, v40, v41, v42
    v_max3_u32 v25, v25, v35, v36
    v_max3_u32 v27, v27, v43, v44
    v_max3_u32 v25, v25, v37, v38
    v_max3_u32 v27, v27, v45, v46
    v_max_u32 v25, v25, v39
    v_max_u32 v27, v27, v47
    v_max_u32 v25, v25, v27
    v_cmp_eq_u32 vcc, -1, v25
    s_cbranch_vccz L_pollx_44
    s_mov_b64 exec, vcc
    s_sleep 2
    s_sub_u32 s68, s68, 1
    s_cbranch_scc0 L_poll_43
L_pollx_44:
    s_mov_b64 exec, s[56:57]
    v_add_f32 v32, v32, v36
    v_add_f32 v33, v33, v37
    v_add_f32 v34, v34, v38
    v_add_f32 v35, v35, v39
    v_add_f32 v40, v40, v44
    v_add_f32 v41, v41, v45
    v_add_f32 v42, v42, v46
    v_add_f32 v43, v43, v47
    v_add_f32 v32, v32, v40
    v_add_f32 v33, v33, v41
    v_add_f32 v34, v34, v42
    v_add_f32 v35, v35, v43
    s_nop 0
    v_permlane32_swap_b32 v32, v34
    v_permlane32_swap_b32 v33, v35
    v_add_f32 v32, v32, v34
    v_add_f32 v33, v33, v35
    v_cvt_pk_bf16_f32 v32, v32, v33
    ds_write_b32 v7, v32 offset:256
    ds_write_b32 v3, v2 offset:0
    s_mov_b32 s68, 2097152
L_spin_45:
    ds_read_b128 v[32:35], v3 offset:16
    ds_read_b128 v[36:39], v3 offset:512
    ds_read_b128 v[40:43], v3 offset:528
    s_waitcnt lgkmcnt(0)
    v_xor_b32 v25, v32, v2
    v_bitop3_b32 v25, v25, v33, v2 bitop3:0xf6
    v_bitop3_b32 v25, v25, v34, v2 bitop3:0xf6
    v_bitop3_b32 v25, v25, v35, v2 bitop3:0xf6
    v_cmp_ne_u32 vcc, 0, v25
    s_cbranch_vccz L_spinx_46
    s_sleep 1
    s_sub_u32 s68, s68, 1
    s_cbranch_scc0 L_spin_45
L_spinx_46:
    v_max3_f32 v44, v36, v37, v38
    v_max_f32 v44, v44, v39
    s_mov_b32 s63, 1069066811
    v_sub_f32 v36, v36, v44
    v_sub_f32 v37, v37, v44
    v_sub_f32 v38, v38, v44
    v_sub_f32 v39, v39, v44
    v_mul_f32 v36, s63, v36
    v_mul_f32 v37, s63, v37
    v_mul_f32 v38, s63, v38
    v_mul_f32 v39, s63, v39
    v_exp_f32 v36, v36
    v_exp_f32 v37, v37
    v_exp_f32 v38, v38
    v_exp_f32 v39, v39
    v_mul_f32 v45, v36, v40
    v_fmac_f32 v45, v37, v41
    v_fmac_f32 v45, v38, v42
    v_fmac_f32 v45, v39, v43
    v_mov_b32 v16, v36
    v_mov_b32 v17, v37
    v_mov_b32 v18, v38
    v_mov_b32 v19, v39
    s_add_u32 s59, s74, 1808
    v_mov_b32 v24, s59
    s_mov_b64 exec, 1
    s_cmp_lg_u32 s69, 0
    s_cbranch_scc0 L_pg_47
    buffer_store_dwordx2 v[44:45], v24, s[36:39], s96 offen
L_pd_48:
    s_mov_b64 exec, -1
    v_lshrrev_b32 v24, 5, v0
    v_lshlrev_b32 v27, 12, v24
    s_add_u32 s59, s58, 1808
    v_add_u32 v27, s59, v27
    v_mov_b32 v158, v27
    v_and_b32 v25, 8, v0
    v_cmp_eq_u32 s[78:79], 0, v25
    v_lshrrev_b32 v24, 4, v0
    v_and_b32 v27, 7, v0
    v_lshl_add_u32 v24, v27, 2, v24
    v_lshlrev_b32 v21, 1, v24
    v_lshl_add_u32 v21, v25, 3, v21
    s_mov_b32 s68, 2097152
L_spin_49:
    ds_read_b32 v32, v3 offset:76
    ds_read_b128 v[36:39], v1 offset:6912
    s_waitcnt lgkmcnt(0)
    v_cmp_ne_u32 vcc, v32, v2
    s_cbranch_vccz L_spinx_50
    s_sleep 1
    s_sub_u32 s68, s68, 1
    s_cbranch_scc0 L_spin_49
L_spinx_50:
    v_mov_b32 v10, v36
    v_mov_b32 v11, v37
    v_mov_b32 v12, v38
    v_mov_b32 v13, v39
    v_lshlrev_b32 v4, 3, v0
    s_add_u32 s59, s74, 512
    v_add_u32 v5, s59, v4
    s_lshr_b32 s60, s88, 1
    s_lshl_b32 s59, s60, 7
    s_add_u32 s59, s59, 131072
    v_lshrrev_b32 v24, 3, v0
    v_lshlrev_b32 v8, 11, v24
    v_and_b32 v25, 7, v0
    v_lshl_add_u32 v8, v25, 4, v8
    v_add_u32 v8, s59, v8
    s_add_u32 s59, s74, 1792
    v_mov_b32 v9, s59
    s_lshl_b32 s65, s89, 2
    s_cmp_ge_u32 s88, s65
    s_cbranch_scc1 L_g_notdn
    s_and_b32 s58, s75, 0xe0
    s_lshl_b32 s58, s58, 12
    s_add_u32 s58, s58, 1048576
    s_add_u32 s58, s58, s69
    s_lshr_b32 s59, s88, 2
    s_lshl_b32 s59, s59, 7
    s_add_u32 s59, s59, s58
    v_lshlrev_b32 v20, 12, v24
    v_lshl_add_u32 v20, v25, 4, v20
    v_add_u32 v20, s59, v20
    v_and_b32 v22, 15, v0
    v_lshlrev_b32 v22, 13, v22
    s_add_u32 s59, s58, 1792
    v_add_u32 v22, s59, v22
    v_subrev_u32 v26, 64, v21
    v_add_u32 v26, 4992, v26
    v_cndmask_b32 v26, v26, v21, s[78:79]
    s_branch L_g_const_done
L_g_notdn:
    s_and_b32 s58, s88, 3
    s_lshl_b32 s59, s7, 2
    s_add_u32 s58, s58, s59
    s_lshl_b32 s59, s58, 6
    v_and_b32 v25, 3, v0
    v_lshl_add_u32 v22, v25, 4, s59
    v_lshrrev_b32 v24, 2, v0
    v_lshl_add_u32 v22, v24, 11, v22
    v_add_u32 v20, 196608, v22
    v_add_u32 v22, 131072, v22
L_g_const_done:
    s_mov_b32 s76, -1
    s_mov_b32 s77, 0xfff
    s_setprio 3
L_gtail:
    s_mov_b32 s68, 2097152
L_spin_51:
    ds_read_b128 v[32:35], v3 offset:32
    ds_read_b64 v[36:37], v4 offset:4096
    ds_read_b64 v[38:39], v4 offset:4608
    ds_read_b64 v[40:41], v4 offset:5120
    ds_read_b64 v[42:43], v4 offset:5632
    s_waitcnt lgkmcnt(0)
    v_xor_b32 v25, v32, v2
    v_bitop3_b32 v25, v25, v33, v2 bitop3:0xf6
    v_bitop3_b32 v25, v25, v34, v2 bitop3:0xf6
    v_bitop3_b32 v25, v25, v35, v2 bitop3:0xf6
    v_cmp_ne_u32 vcc, 0, v25
    s_cbranch_vccz L_spinx_52
    s_sub_u32 s68, s68, 1
    s_cbranch_scc0 L_spin_51
L_spinx_52:
    v_mul_f32 v44, v16, v36
    v_mul_f32 v45, v16, v37
    v_fmac_f32 v44, v17, v38
    v_fmac_f32 v45, v17, v39
    v_fmac_f32 v44, v18, v40
    v_fmac_f32 v45, v18, v41
    v_fmac_f32 v44, v19, v42
    v_fmac_f32 v45, v19, v43
    s_cmp_lg_u32 s69, 0
    s_cbranch_scc0 L_pg_53
    buffer_store_dwordx2 v[44:45], v5, s[36:39], s96 offen
L_pd_54:
    s_mov_b32 s68, 262144
L_poll_55:
    s_mov_b32 s62, 0
    buffer_load_dwordx4 v[64:67], v6, s[36:39], s62 offen offset:512 sc1
    s_mov_b32 s62, 8192
    buffer_load_dwordx4 v[68:71], v6, s[36:39], s62 offen offset:512 sc1
    s_mov_b32 s62, 16384
    buffer_load_dwordx4 v[72:75], v6, s[36:39], s62 offen offset:512 sc1
    s_mov_b32 s62, 24576
    buffer_load_dwordx4 v[76:79], v6, s[36:39], s62 offen offset:512 sc1
    s_mov_b32 s62, 0
    buffer_load_dwordx2 v[80:81], v158, s[36:39], s62 offen sc1
    s_mov_b32 s62, 8192
    buffer_load_dwordx2 v[82:83], v158, s[36:39], s62 offen sc1
    s_mov_b32 s62, 16384
    buffer_load_dwordx2 v[84:85], v158, s[36:39], s62 offen sc1
    s_mov_b32 s62, 24576
    buffer_load_dwordx2 v[86:87], v158, s[36:39], s62 offen sc1
    s_cbranch_execz L_nw_57
    s_waitcnt vmcnt(0)
L_nw_57:
    v_max3_u32 v25, v64, v65, v66
    v_max3_u32 v27, v76, v77, v78
    v_max3_u32 v25, v25, v67, v68
    v_max3_u32 v27, v27, v79, v80
    v_max3_u32 v25, v25, v69, v70
    v_max3_u32 v27, v27, v81, v82
    v_max3_u32 v25, v25, v71, v72
    v_max3_u32 v27, v27, v83, v84
    v_max3_u32 v25, v25, v73, v74
    v_max3_u32 v27, v27, v85, v86
    v_max_u32 v25, v25, v75
    v_max_u32 v27, v27, v87
    v_max_u32 v25, v25, v27
    v_cmp_eq_u32 vcc, -1, v25
    s_cbranch_vccz L_pollx_56
    s_mov_b64 exec, vcc
    s_sub_u32 s68, s68, 1
    s_cbranch_scc0 L_poll_55
L_pollx_56:
    s_mov_b64 exec, s[56:57]
    v_max3_f32 v40, v80, v82, v84
    v_max_f32 v40, v40, v86
    v_mov_b32 v41, v40
    s_mov_b32 s63, 1069066811
    s_nop 0
    v_permlane32_swap_b32 v40, v41
    v_max_f32 v40, v40, v41
    v_sub_f32 v32, v80, v40
    v_sub_f32 v33, v82, v40
    v_sub_f32 v34, v84, v40
    v_sub_f32 v35, v86, v40
    v_mul_f32 v32, s63, v32
    v_mul_f32 v33, s63, v33
    v_mul_f32 v34, s63, v34
    v_mul_f32 v35, s63, v35
    v_exp_f32 v32, v32
    v_exp_f32 v33, v33
    v_exp_f32 v34, v34
    v_exp_f32 v35, v35
    v_mul_f32 v40, v32, v81
    v_mul_f32 v48, v32, v64
    v_mul_f32 v49, v32, v65
    v_mul_f32 v50, v32, v66
    v_mul_f32 v51, v32, v67
    v_fmac_f32 v40, v33, v83
    v_mul_f32 v52, v33, v68
    v_mul_f32 v53, v33, v69
    v_mul_f32 v54, v33, v70
    v_mul_f32 v55, v33, v71
    v_fmac_f32 v40, v34, v85
    v_fmac_f32 v48, v34, v72
    v_fmac_f32 v49, v34, v73
    v_fmac_f32 v50, v34, v74
    v_fmac_f32 v51, v34, v75
    v_fmac_f32 v40, v35, v87
    v_fmac_f32 v52, v35, v76
    v_fmac_f32 v53, v35, v77
    v_fmac_f32 v54, v35, v78
    v_fmac_f32 v55, v35, v79
    v_mov_b32 v41, v40
    v_add_f32 v48, v48, v52
    v_add_f32 v49, v49, v53
    v_add_f32 v50, v50, v54
    v_add_f32 v51, v51, v55
    v_permlane32_swap_b32 v40, v41
    v_permlane32_swap_b32 v48, v50
    v_permlane32_swap_b32 v49, v51
    v_add_f32 v40, v40, v41
    v_add_f32 v48, v48, v50
    v_add_f32 v49, v49, v51
    v_rcp_f32 v41, v40
    s_nop 0
    v_fma_f32 v42, -v40, v41, 1.0
    v_fma_f32 v41, v42, v41, v41
    v_mul_f32 v48, v48, v41
    v_mul_f32 v49, v49, v41
    v_cvt_pk_bf16_f32 v48, v48, v49
    ds_write_b32 v7, v48 offset:1280
    ds_write_b32 v3, v2 offset:80
    s_mov_b32 s68, 262144
L_poll_58:
    s_mov_b32 s62, 0
    buffer_load_dwordx4 v[64:67], v8, s[36:39], s62 offen sc1
    s_mov_b32 s62, 16384
    buffer_load_dwordx4 v[68:71], v8, s[36:39], s62 offen sc1
    s_mov_b32 s62, 32768
    buffer_load_dwordx4 v[72:75], v8, s[36:39], s62 offen sc1
    s_mov_b32 s62, 49152
    buffer_load_dwordx4 v[76:79], v8, s[36:39], s62 offen sc1
    s_cbranch_execz L_nw_60
    s_waitcnt vmcnt(0)
L_nw_60:
    v_max3_u32 v25, v64, v65, v66
    v_max3_u32 v27, v72, v73, v74
    v_max3_u32 v25, v25, v67, v68
    v_max3_u32 v27, v27, v75, v76
    v_max3_u32 v25, v25, v69, v70
    v_max3_u32 v27, v27, v77, v78
    v_max_u32 v25, v25, v71
    v_max_u32 v27, v27, v79
    v_max_u32 v25, v25, v27
    v_cmp_eq_u32 vcc, -1, v25
    s_cbranch_vccz L_pollx_59
    s_mov_b64 exec, vcc
    s_sleep 2
    s_sub_u32 s68, s68, 1
    s_cbranch_scc0 L_poll_58
L_pollx_59:
    s_mov_b64 exec, s[56:57]
    v_add_f32 v32, v64, v68
    v_add_f32 v33, v65, v69
    v_add_f32 v34, v66, v70
    v_add_f32 v35, v67, v71
    v_add_f32 v36, v72, v76
    v_add_f32 v37, v73, v77
    v_add_f32 v38, v74, v78
    v_add_f32 v39, v75, v79
    v_add_f32 v32, v32, v36
    v_add_f32 v33, v33, v37
    v_add_f32 v34, v34, v38
    v_add_f32 v35, v35, v39
    s_nop 0
    v_permlane32_swap_b32 v32, v34
    v_permlane32_swap_b32 v33, v35
    v_add_f32 v32, v32, v34
    v_add_f32 v33, v33, v35
    s_nop 1
    v_permlane16_swap_b32 v32, v33
    v_add_f32 v32, v32, v33
    s_nop 1
    v_add_f32_dpp v32, v32, v32 row_ror:8 row_mask:0xf bank_mask:0xf
    v_cvt_pk_bf16_f32 v32, v32, v32
    v_and_b32 v32, 0xffff0000, v32
    v_mul_f32 v32, v32, v10
    v_cvt_pk_bf16_f32 v32, v32, v32
    v_and_b32 v32, 0xffff0000, v32
    v_add_f32 v32, v32, v14
    v_cvt_pk_bf16_f32 v32, v32, v32
    v_and_b32 v32, 0xffff0000, v32
    v_mul_f32 v33, v32, v11
    v_cvt_pk_bf16_f32 v34, v33, v33
    v_and_b32 v35, 0xffff0000, v34
    v_sub_f32 v35, v33, v35
    v_cndmask_b32 v35, v35, v33, s[78:79]
    v_cvt_pk_bf16_f32 v35, v35, v35
    ds_write_b16 v21, v35 offset:1536
    ds_write_b32 v3, v2 offset:84
    v_mov_b32 v36, v32
    s_nop 1
    v_add_f32_dpp v36, v36, v36 quad_perm:[1,0,3,2] row_mask:0xf bank_mask:0xf
    s_nop 1
    v_add_f32_dpp v36, v36, v36 quad_perm:[2,3,0,1] row_mask:0xf bank_mask:0xf
    s_nop 1
    v_add_f32_dpp v36, v36, v36 row_half_mirror row_mask:0xf bank_mask:0xf
    v_mov_b32 v25, v36
    s_nop 1
    v_permlane16_swap_b32 v36, v25
    v_add_f32 v36, v36, v25
    v_mov_b32 v25, v36
    s_nop 1
    v_permlane32_swap_b32 v36, v25
    v_add_f32 v36, v36, v25
    v_mul_f32 v36, 0x3d000000, v36
    v_sub_f32 v38, v32, v36
    v_mul_f32 v37, v38, v38
    s_nop 1
    v_add_f32_dpp v37, v37, v37 quad_perm:[1,0,3,2] row_mask:0xf bank_mask:0xf
    s_nop 1
    v_add_f32_dpp v37, v37, v37 quad_perm:[2,3,0,1] row_mask:0xf bank_mask:0xf
    s_nop 1
    v_add_f32_dpp v37, v37, v37 row_half_mirror row_mask:0xf bank_mask:0xf
    v_mov_b32 v25, v37
    s_nop 1
    v_permlane16_swap_b32 v37, v25
    v_add_f32 v37, v37, v25
    v_mov_b32 v25, v37
    s_nop 1
    v_permlane32_swap_b32 v37, v25
    v_add_f32 v37, v37, v25
    s_and_b64 exec, s[56:57], 1
    s_cmp_lg_u32 s69, 0
    s_cbranch_scc0 L_pg_61
    buffer_store_dwordx2 v[36:37], v9, s[36:39], s96 offen
L_pd_62:
    s_mov_b64 exec, s[56:57]
    s_cmp_ge_u32 s88, s65
    s_cbranch_scc1 L_g_fin
    s_mov_b32 s68, 2097152
L_spin_63:
    ds_read_b32 v32, v3 offset:120
    ds_read_b64 v[156:157], v4 offset:6144
    s_waitcnt lgkmcnt(0)
    v_cmp_ne_u32 vcc, v32, v2
    s_cbranch_vccz L_spinx_64
    s_sub_u32 s68, s68, 1
    s_cbranch_scc0 L_spin_63
L_spinx_64:
    s_mov_b32 s68, 262144
L_poll_65:
    s_mov_b32 s62, 0
    buffer_load_dwordx4 v[64:67], v20, s[36:39], s62 offen offset:1024 sc1
    s_mov_b32 s62, 32768
    buffer_load_dwordx4 v[68:71], v20, s[36:39], s62 offen offset:1024 sc1
    s_mov_b32 s62, 65536
    buffer_load_dwordx4 v[72:75], v20, s[36:39], s62 offen offset:1024 sc1
    s_mov_b32 s62, 98304
    buffer_load_dwordx4 v[76:79], v20, s[36:39], s62 offen offset:1024 sc1
    buffer_load_dwordx2 v[80:81], v22, s[36:39], 0 offen sc1
    s_cbranch_execz L_nw_67
    s_waitcnt vmcnt(0)
L_nw_67:
    v_max3_u32 v25, v64, v65, v66
    v_max3_u32 v27, v73, v74, v75
    v_max3_u32 v25, v25, v67, v68
    v_max3_u32 v27, v27, v76, v77
    v_max3_u32 v25, v25, v69, v70
    v_max3_u32 v27, v27, v78, v79
    v_max3_u32 v25, v25, v71, v72
    v_max3_u32 v27, v27, v80, v81
    v_max_u32 v25, v25, v27
    v_cmp_eq_u32 vcc, -1, v25
    s_cbranch_vccz L_pollx_66
    s_mov_b64 exec, vcc
    s_sub_u32 s68, s68, 1
    s_cbranch_scc0 L_poll_65
L_pollx_66:
    s_mov_b64 exec, s[56:57]
    v_mov_b32 v48, v80
    v_mov_b32 v49, v81
    v_add_f32 v32, v64, v68
    v_add_f32 v33, v65, v69
    v_add_f32 v34, v66, v70
    v_add_f32 v35, v67, v71
    v_add_f32 v36, v72, v76
    v_add_f32 v37, v73, v77
    v_add_f32 v38, v74, v78
    v_add_f32 v39, v75, v79
    v_add_f32 v32, v32, v36
    v_add_f32 v33, v33, v37
    v_add_f32 v34, v34, v38
    v_add_f32 v35, v35, v39
    s_mov_b32 s63, 0x42000000
    v_mul_f32 v50, v48, v48
    v_fma_f32 v49, v50, s63, v49
    v_permlane32_swap_b32 v32, v34
    v_permlane32_swap_b32 v33, v35
    v_add_f32_dpp v48, v48, v48 quad_perm:[1,0,3,2] row_mask:0xf bank_mask:0xf
    v_add_f32 v32, v32, v34
    v_add_f32 v33, v33, v35
    v_add_f32_dpp v49, v49, v49 quad_perm:[1,0,3,2] row_mask:0xf bank_mask:0xf
    s_nop 0
    v_permlane16_swap_b32 v32, v33
    v_add_f32 v32, v32, v33
    v_add_f32_dpp v48, v48, v48 quad_perm:[2,3,0,1] row_mask:0xf bank_mask:0xf
    v_add_f32_dpp v49, v49, v49 quad_perm:[2,3,0,1] row_mask:0xf bank_mask:0xf
    s_nop 0
    v_add_f32_dpp v48, v48, v48 row_half_mirror row_mask:0xf bank_mask:0xf
    v_add_f32_dpp v49, v49, v49 row_half_mirror row_mask:0xf bank_mask:0xf
    s_nop 0
    v_add_f32_dpp v48, v48, v48 row_mirror row_mask:0xf bank_mask:0xf
    v_add_f32_dpp v49, v49, v49 row_mirror row_mask:0xf bank_mask:0xf
    v_mul_f32 v48, 0x3d800000, v48
    v_mul_f32 v49, 0x3b000000, v49
    v_fma_f32 v49, -v48, v48, v49
    v_cvt_pk_bf16_f32 v49, v49, v49
    v_and_b32 v49, 0xffff0000, v49
    v_add_f32 v49, 0x3727c5ac, v49
    v_cvt_pk_bf16_f32 v49, v49, v49
    v_and_b32 v49, 0xffff0000, v49
    v_sqrt_f32 v49, v49
    s_nop 0
    v_cvt_pk_bf16_f32 v49, v49, v49
    v_and_b32 v49, 0xffff0000, v49
    v_cvt_pk_bf16_f32 v48, v48, v48
    v_and_b32 v48, 0xffff0000, v48
    v_rcp_f32 v51, v49
    v_fma_f32 v32, -v48, v156, v32
    v_fma_f32 v52, -v49, v51, 1.0
    v_fma_f32 v51, v52, v51, v51
    v_fma_f32 v32, v32, v51, v157
    v_cvt_pk_bf16_f32 v32, v32, v32
    v_and_b32 v32, 0xffff0000, v32
    s_mov_b32 s63, 0x3d372713
    s_mov_b32 s64, 0xc0135761
    v_mul_f32 v33, v32, v32
    v_mul_f32 v33, v33, v32
    v_fma_f32 v33, v33, s63, v32
    v_mul_f32 v33, s64, v33
    v_exp_f32 v33, v33
    s_nop 0
    v_add_f32 v33, 1.0, v33
    v_rcp_f32 v33, v33
    s_nop 0
    v_mul_f32 v33, v32, v33
    v_cvt_pk_bf16_f32 v33, v33, v33
    v_and_b32 v33, 0xffff0000, v33
    s_nop 1
    v_mul_f32_dpp v33, v32, v33 row_ror:8 row_mask:0xf bank_mask:0xf
    v_cvt_pk_bf16_f32 v33, v33, v33
    ds_write_b16 v26, v33 offset:1664
    ds_write_b32 v3, v2 offset:88
    s_branch L_gtail_end
L_g_fin:
    s_cmp_lt_u32 s88, 24
    s_cbranch_scc1 L_gtail_end
    s_cmp_ge_u32 s88, 28
    s_cbranch_scc1 L_gtail_end
    s_mov_b32 s68, 262144
L_poll_68:
    s_mov_b32 s62, 0
    buffer_load_dwordx4 v[32:35], v22, s[36:39], s62 offen sc1
    s_mov_b32 s62, 32768
    buffer_load_dwordx4 v[36:39], v22, s[36:39], s62 offen sc1
    s_cbranch_execz L_nw_70
    s_waitcnt vmcnt(0)
L_nw_70:
    v_max3_u32 v25, v32, v33, v34
    v_max3_u32 v27, v36, v37, v38
    v_max_u32 v25, v25, v35
    v_max_u32 v27, v27, v39
    v_max_u32 v25, v25, v27
    v_cmp_eq_u32 vcc, -1, v25
    s_cbranch_vccz L_pollx_69
    s_mov_b64 exec, vcc
    s_sub_u32 s68, s68, 1
    s_cbranch_scc0 L_poll_68
L_pollx_69:
    s_mov_b64 exec, s[56:57]
    v_add_f32 v32, v32, v36
    v_add_f32 v33, v33, v37
    v_add_f32 v34, v34, v38
    v_add_f32 v35, v35, v39
    s_nop 0
    v_permlane32_swap_b32 v32, v34
    v_permlane32_swap_b32 v33, v35
    v_add_f32 v32, v32, v34
    v_add_f32 v33, v33, v35
    s_nop 1
    v_permlane16_swap_b32 v32, v33
    v_add_f32 v32, v32, v33
    s_nop 1
    v_add_f32_dpp v32, v32, v32 row_ror:4 row_mask:0xf bank_mask:0xf
    s_nop 1
    v_add_f32_dpp v32, v32, v32 row_ror:8 row_mask:0xf bank_mask:0xf
    v_cvt_pk_bf16_f32 v32, v32, v32
    v_and_b32 v32, 0xffff0000, v32
    v_mul_f32 v32, v32, v12
    v_cvt_pk_bf16_f32 v32, v32, v32
    v_and_b32 v32, 0xffff0000, v32
    v_add_f32 v16, v32, v15
    v_cvt_pk_bf16_f32 v16, v16, v16
    v_and_b32 v16, 0xffff0000, v16
    s_waitcnt vmcnt(0)
    v_mov_b32 v72, 0
    v_mov_b32 v73, 0
    v_mov_b32 v74, 0
    v_mov_b32 v75, 0
    v_mov_b32 v104, 0
    v_mov_b32 v105, 0
    v_mov_b32 v106, 0
    v_mov_b32 v107, 0
    s_mov_b32 s68, 262144
L_poll_71:
    s_mov_b32 s62, 0
    buffer_load_dwordx4 v[64:67], v20, s[36:39], s62 offen sc1
    s_mov_b32 s62, 32768
    buffer_load_dwordx4 v[68:71], v20, s[36:39], s62 offen sc1
    s_mov_b32 s62, 65536
    s_mov_b64 s[60:61], exec
    s_and_b64 exec, exec, s[76:77]
    buffer_load_dwordx4 v[72:75], v20, s[36:39], s62 offen sc1
    s_mov_b64 exec, s[60:61]
    s_cbranch_execz L_nw_73
    s_waitcnt vmcnt(0)
L_nw_73:
    v_max3_u32 v25, v64, v65, v66
    v_max3_u32 v27, v70, v71, v72
    v_max3_u32 v25, v25, v67, v68
    v_max3_u32 v27, v27, v73, v74
    v_max_u32 v25, v25, v69
    v_max_u32 v27, v27, v75
    v_max_u32 v25, v25, v27
    v_cmp_eq_u32 vcc, -1, v25
    s_cbranch_vccz L_pollx_72
    s_mov_b64 exec, vcc
    s_sub_u32 s68, s68, 1
    s_cbranch_scc0 L_poll_71
L_pollx_72:
    s_mov_b64 exec, s[56:57]
    v_add_f32 v32, v64, v68
    v_add_f32 v33, v65, v69
    v_add_f32 v34, v66, v70
    v_add_f32 v35, v67, v71
    v_add_f32 v32, v32, v72
    v_add_f32 v33, v33, v73
    v_add_f32 v34, v34, v74
    v_add_f32 v35, v35, v75
    s_nop 0
    v_permlane32_swap_b32 v32, v34
    v_permlane32_swap_b32 v33, v35
    v_add_f32 v32, v32, v34
    v_add_f32 v33, v33, v35
    s_nop 1
    v_permlane16_swap_b32 v32, v33
    v_add_f32 v32, v32, v33
    s_nop 1
    v_add_f32_dpp v32, v32, v32 row_ror:4 row_mask:0xf bank_mask:0xf
    s_nop 1
    v_add_f32_dpp v32, v32, v32 row_ror:8 row_mask:0xf bank_mask:0xf
    v_cvt_pk_bf16_f32 v32, v32, v32
    v_and_b32 v32, 0xffff0000, v32
    v_mul_f32 v32, v32, v13
    v_cvt_pk_bf16_f32 v32, v32, v32
    v_and_b32 v32, 0xffff0000, v32
    v_add_f32 v32, v32, v16
    v_cvt_pk_bf16_f32 v32, v32, v32
    s_mov_b32 s60, 0xf000f
    s_mov_b32 s61, 0xf000f
    s_and_b64 exec, s[56:57], s[60:61]
    buffer_store_short v32, v23, s[44:47], 0 offen
    s_mov_b64 exec, s[56:57]
    s_cmp_lg_u32 s2, 192
    s_cbranch_scc1 L_g_noepoch
    s_and_b64 exec, s[56:57], 1
    buffer_store_dword v2, v3, s[36:39], 0 offen sc1
    s_mov_b64 exec, s[56:57]
L_g_noepoch:
L_gtail_end:
    s_cbranch_execz L_gtail_ret
    s_endpgm
L_pg_11:
    s_nop 7
    buffer_store_dwordx4 v[64:67], v151, s[36:39], 0 offen sc1
    buffer_store_dwordx4 v[68:71], v151, s[36:39], 0 offen offset:64 sc1
    buffer_store_dwordx4 v[72:75], v151, s[36:39], 0 offen offset:128 sc1
    s_branch L_pd_12
L_pg_15:
    s_nop 7
    buffer_store_dwordx4 v[64:67], v146, s[36:39], 0 offen sc1
    buffer_store_dwordx4 v[68:71], v146, s[36:39], 0 offen offset:64 sc1
    buffer_store_dwordx4 v[72:75], v146, s[36:39], 0 offen offset:128 sc1
    s_branch L_pd_16
L_pg_39:
    s_nop 7
    buffer_store_dword v132, v25, s[36:39], 0 offen sc1
    s_branch L_pd_40
L_pg_41:
    s_nop 7
    buffer_store_dword v133, v25, s[36:39], 0 offen offset:256 sc1
    s_branch L_pd_42
L_pg_47:
    s_nop 7
    buffer_store_dwordx2 v[44:45], v24, s[36:39], 0 offen sc1
    s_branch L_pd_48
L_pg_53:
    s_nop 7
    buffer_store_dwordx2 v[44:45], v5, s[36:39], 0 offen sc1
    s_branch L_pd_54
L_pg_61:
    s_nop 7
    buffer_store_dwordx2 v[36:37], v9, s[36:39], 0 offen sc1
    s_branch L_pd_62
L_end:
    s_endpgm
L_code_end:
.section .rodata,"a"
.p2align 6
.amdhsa_kernel adaLN_cond__gqa_block_cached__glu_gated_geglu__decode_kernel
  .amdhsa_next_free_vgpr 168
  .amdhsa_next_free_sgpr 100
  .amdhsa_accum_offset 168
  .amdhsa_group_segment_fixed_size 0
  .amdhsa_kernarg_size 112
  .amdhsa_user_sgpr_count 2
  .amdhsa_user_sgpr_kernarg_segment_ptr 1
  .amdhsa_system_sgpr_workgroup_id_x 1
.end_amdhsa_kernel
```
